```python
import torch

def _softmax(x, axis=-1):
    return torch.softmax(x, dim=axis)
def _gelu(x):
    return torch.nn.functional.gelu(x, approximate="tanh")
def _silu(x):
    return torch.nn.functional.silu(x)
def _sigmoid(x):
    return torch.sigmoid(x)
def _layernorm(x, axis=-1, eps=1e-5):
    m = x.mean(dim=axis, keepdim=True)
    v = x.var(dim=axis, keepdim=True, unbiased=False)
    return (x - m) / torch.sqrt(v + eps)
def _scatter_add(tgt, idx, src, axis=0):
    return tgt.clone().index_add_(axis, idx, src)
def _segment_sum(src, seg, n):
    out = torch.zeros((n,) + src.shape[1:], dtype=src.dtype)
    return out.index_add_(0, seg, src)
def _pad(x, pw):
    flat = tuple(v for pair in reversed(pw) for v in pair)
    return torch.nn.functional.pad(x, flat)

kernel_name = 'parallel_sum__sliding_block__dense_activation_silu__prompt'

def setup_inputs():

    _w = (lambda a: (lambda t: t.to(torch.bfloat16) if t.is_floating_point() else t)(torch.as_tensor(a)))
    def _A_setup():
        B, S, D = 1, 2048, 640
        return {
            "x": _w((lambda *s: torch.randn(*s, dtype=torch.bfloat16) * 0.05)(B, S, D)),
            "wqkv": _w((lambda *s: torch.randn(*s, dtype=torch.bfloat16) * 0.05)(D, 3 * D)),
            "wo": _w((lambda *s: torch.randn(*s, dtype=torch.bfloat16) * 0.05)(D, D)),
        }
    _A_in = _A_setup()

    def _B_setup():
        B, S, D, F = 1, 2048, 640, 1728
        return {
            "x": _w((lambda *s: torch.randn(*s, dtype=torch.bfloat16) * 0.05)(B, S, D)),
            "w1": _w((lambda *s: torch.randn(*s, dtype=torch.bfloat16) * 0.8)(D, F) * (D ** -0.5)),
            "w2": _w((lambda *s: torch.randn(*s, dtype=torch.bfloat16) * 0.8)(F, D) * (F ** -0.5)),
        }
    _B_in = _B_setup()

    return {
        "A_x": _A_in["x"],
        "A_wqkv": _A_in["wqkv"],
        "A_wo": _A_in["wo"],
        "B_x": _B_in["x"],
        "B_w1": _B_in["w1"],
        "B_w2": _B_in["w2"],
    }

def reference(A_x, A_wqkv, A_wo, B_x, B_w1, B_w2):
    def _A_ref(x, wqkv, wo):
        B, S, D = x.shape
        H = 32; Dh = D // H; W = 256
        qkv = (lambda x, *d: x.permute(*d))((x @ wqkv).reshape(B, S, 3, H, Dh), 2, 0, 3, 1, 4)
        q, k, v = qkv[0], qkv[1], qkv[2]
        scores = torch.einsum("bhqd,bhkd->bhqk", q, k) * (Dh ** -0.5)
        idx = torch.arange(S)
        mask = (idx[:, None] - idx[None, :] >= 0) & (idx[:, None] - idx[None, :] < W)
        scores = torch.where(mask[None, None], scores, -1e9)
        p = _softmax(scores, axis=-1)
        o = torch.einsum("bhqk,bhkd->bhqd", p, v)
        return (lambda x, *d: x.permute(*d))(o, 0, 2, 1, 3).reshape(B, S, D) @ wo

    def _B_ref(x, w1, w2):
        h = torch.einsum("bsd,df->bsf", x, w1)
        h = _silu(h)
        out = torch.einsum("bsf,fd->bsd", h, w2)
        return out

    x = A_x
    xn = _layernorm(x, axis=-1)
    return x + _A_ref(xn, A_wqkv, A_wo) + _B_ref(xn, B_w1, B_w2)
```

```asm
; @launch grid=(256,1,1) block=(512,1,1) lds=163840
.amdgcn_target "amdgcn-amd-amdhsa--gfx950"
.text
.globl parallel_sum__sliding_block__dense_activation_silu__prompt_kernel
.p2align 8
.type parallel_sum__sliding_block__dense_activation_silu__prompt_kernel,@function
parallel_sum__sliding_block__dense_activation_silu__prompt_kernel:
    s_cmp_ge_u32 s2, 256
    s_cbranch_scc1 L_end
    s_load_dwordx2 s[4:5], s[0:1], 0
    s_load_dwordx2 s[8:9], s[0:1], 8
    s_load_dwordx2 s[16:17], s[0:1], 64
    s_load_dwordx2 s[12:13], s[0:1], 32
    s_load_dwordx2 s[20:21], s[0:1], 48
    s_load_dwordx2 s[80:81], s[0:1], 56
    s_load_dwordx2 s[28:29], s[0:1], 16
    s_load_dwordx2 s[30:31], s[0:1], 40
    v_lshrrev_b32 v1, 6, v0
    v_and_b32 v0, 63, v0
    v_readfirstlane_b32 s33, v1
    s_and_b32 s46, s2, 1
    s_bfe_u32 s49, s2, 0x30003
    s_lshl3_add_u32 s36, s46, s49
    s_bfe_u32 s48, s2, 0x20001
    s_lshr_b32 s50, s2, 6
    s_lshl2_add_u32 s37, s50, s48
    s_lshl2_add_u32 s38, s48, s50
    s_mul_i32 s49, s49, 5
    s_lshr_b32 s49, s49, 2
    s_mul_i32 s51, s50, 5
    s_lshr_b32 s51, s51, 1
    s_add_u32 s88, s51, s49
    s_sub_u32 s51, s88, 10
    s_cselect_b32 s88, s88, s51
    s_and_b32 s34, s33, 3
    s_lshr_b32 s35, s33, 2
    s_lshl_b32 s39, s33, 11
    v_lshrrev_b32 v2, 4, v0
    v_lshrrev_b32 v3, 3, v0
    v_and_b32 v4, 7, v0
    v_xor_b32 v5, v4, v2
    v_mul_u32_u24 v6, 0x500, v3
    v_lshl_add_u32 v248, v5, 4, v6
    v_xor_b32 v249, 64, v248
    v_add_u32 v249, 9216, v249
    v_and_b32 v7, 3, v3
    v_lshrrev_b32 v8, 5, v0
    v_lshl_add_u32 v7, v8, 3, v7
    v_lshlrev_b32 v8, 1, v2
    v_xor_b32 v8, v4, v8
    v_lshlrev_b32 v8, 4, v8
    v_mul_u32_u24 v9, 0xf00, v7
    v_add_u32 v250, v9, v8
    s_lshl3_add_u32 s49, s36, s33
    s_mul_i32 s41, s49, 20480
    s_lshl_b32 s46, s88, 7
    s_add_u32 s41, s41, s46
    s_lshr_b32 s49, s34, 1
    s_and_b32 s50, s34, 1
    s_lshl3_add_u32 s49, s49, s50
    s_lshl_b32 s49, s49, 2
    s_lshl_b32 s46, s88, 6
    s_add_u32 s46, s46, s49
    s_mul_i32 s42, s46, 3840
    s_cmp_lt_u32 s37, 15
    s_cselect_b32 s50, s37, s36
    s_lshl1_add_u32 s50, s50, s35
    s_lshl_b32 s51, s50, 7
    s_add_u32 s42, s42, s51
    s_sub_u32 s40, 10, s88
    s_movk_i32 s43, 128
    s_mov_b32 s44, 245760
    s_mov_b32 s6, 0x280000
    s_mov_b32 s7, 0x20000
    s_cmp_lt_u32 s37, 15
    s_cselect_b32 s10, 0x258000, 0
    s_mov_b32 s11, 0x20000
    s_mov_b32 s18, 0x13e4000
    s_mov_b32 s19, 0x20000
    v_lshlrev_b32 v10, 4, v0
    v_add_u32 v11, 0x400, v10
    v_mov_b32 v12, 0x80000000
    v_cmp_gt_u32 s[76:77], 16, v0
    v_cmp_eq_u32 vcc, 0, v0
    s_lshl4_add_u32 s47, s36, s37
    s_lshl3_add_u32 s47, s47, s33
    v_cndmask_b32 v11, v12, v11, s[76:77]
    v_cndmask_b32 v254, v12, v0, vcc
    s_mul_i32 s72, s47, 1280
    s_lshl_b32 s45, s47, 4
    s_add_u32 s45, s45, 0x30000
    s_waitcnt lgkmcnt(0)
    buffer_load_dwordx4 v[140:143], v10, s[4:7], s72 offen
    buffer_load_dwordx4 v[144:147], v11, s[4:7], s72 offen
    buffer_load_dword v139, v254, s[16:19], 0 offen
    s_add_u32 m0, s39, 65536
    s_nop 0
    buffer_load_dwordx4 v248, s[4:7], s41 offen lds
    buffer_load_dwordx4 v249, s[4:7], s41 offen offset:1024 lds
    s_cmp_eq_u32 s40, 1
    s_cselect_b32 s46, 0xfffffb80, s43
    s_add_u32 s41, s41, s46
    s_add_u32 m0, s39, 0
    s_add_u32 s47, s42, 60416
    buffer_load_dwordx4 v250, s[8:11], s42 offen lds
    buffer_load_dwordx4 v250, s[8:11], s47 offen offset:1024 lds
    s_cmp_eq_u32 s40, 1
    s_cselect_b32 s46, 0xffde4000, s44
    s_add_u32 s42, s42, s46
    v_mul_u32_u24 v9, 0xd80, v7
    v_add_u32 v251, v9, v8
    v_mul_u32_u24 v9, 0x500, v7
    v_add_u32 v241, v9, v8
    s_mul_i32 s73, s49, 3456
    s_add_u32 s46, s34, 0
    s_and_b32 s52, s46, 3
    s_add_u32 s46, s34, 1
    s_and_b32 s53, s46, 3
    s_add_u32 s46, s34, 2
    s_and_b32 s54, s46, 3
    s_add_u32 s46, s34, 3
    s_and_b32 s55, s46, 3
    v_bfe_u32 v13, v0, 2, 2
    v_and_b32 v14, 1, v2
    v_lshl_add_u32 v13, v14, 2, v13
    v_lshrrev_b32 v14, 1, v13
    v_lshlrev_b32 v13, 7, v13
    v_lshrrev_b32 v15, 1, v2
    v_lshl_add_u32 v13, v15, 10, v13
    v_and_b32 v16, 3, v0
    v_lshl_add_u32 v13, v16, 3, v13
    s_lshl_b32 s46, s35, 13
    v_add_u32 v17, s46, v13
    v_xor_b32 v16, s52, v14
    v_lshl_add_u32 v242, v16, 5, v17
    v_xor_b32 v16, s53, v14
    v_lshl_add_u32 v243, v16, 5, v17
    v_xor_b32 v16, s54, v14
    v_lshl_add_u32 v244, v16, 5, v17
    v_xor_b32 v16, s55, v14
    v_lshl_add_u32 v245, v16, 5, v17
    v_and_b32 v1, 15, v0
    v_lshrrev_b32 v16, 1, v1
    v_xor_b32 v16, v16, v2
    v_lshlrev_b32 v16, 4, v16
    v_lshl_add_u32 v16, v1, 7, v16
    s_lshl_b32 s46, s34, 12
    s_add_u32 s46, s46, 65536
    v_add_u32 v246, s46, v16
    v_xor_b32 v247, 64, v246
    v_lshlrev_b32 v253, 4, v2
    v_mov_b32 v138, v0
    v_mov_b32 v232, 0x44444444
    s_mov_b32 exec_lo, 0xaaaaaaaa
    s_mov_b32 exec_hi, 0xaaaaaaaa
    v_mov_b32 v232, 0xeeeeeeee
    s_mov_b64 exec, -1
    v_mov_b32 v224, 0
    v_mov_b32 v225, 0
    v_mov_b32 v226, 0
    v_mov_b32 v227, 0
    v_mov_b32 v228, 0x3f803f80
    v_mov_b32 v229, 0x3f803f80
    v_mov_b32 v230, 0x3f803f80
    v_mov_b32 v231, 0x3f803f80
    s_mov_b32 s14, 0x21c000
    s_mov_b32 s15, 0x20000
    s_mov_b32 s22, 0x280000
    s_mov_b32 s23, 0x20000
    s_lshl_b32 s70, s37, 7
    s_add_u32 s73, s73, s70
    s_add_u32 s71, s88, s35
    s_sub_u32 s70, s71, 10
    s_cselect_b32 s71, s71, s70
    s_mul_i32 s70, s71, 221184
    s_add_u32 s90, s70, s73
    s_add_u32 s95, s90, 2048
    s_add_u32 s71, s71, 2
    s_sub_u32 s70, s71, 10
    s_cselect_b32 s71, s71, s70
    s_mul_i32 s70, s71, 221184
    s_add_u32 s91, s70, s73
    s_add_u32 s96, s91, 2048
    s_add_u32 s71, s71, 2
    s_sub_u32 s70, s71, 10
    s_cselect_b32 s71, s71, s70
    s_mul_i32 s70, s71, 221184
    s_add_u32 s92, s70, s73
    s_add_u32 s97, s92, 2048
    s_add_u32 s71, s71, 2
    s_sub_u32 s70, s71, 10
    s_cselect_b32 s71, s71, s70
    s_mul_i32 s70, s71, 221184
    s_add_u32 s93, s70, s73
    s_add_u32 s98, s93, 2048
    s_add_u32 s71, s71, 2
    s_sub_u32 s70, s71, 10
    s_cselect_b32 s71, s71, s70
    s_mul_i32 s70, s71, 221184
    s_add_u32 s94, s70, s73
    s_add_u32 s99, s94, 2048
    s_cmp_lt_u32 s37, 11
    s_cselect_b32 s95, s95, 0x80000000
    s_cselect_b32 s96, s96, 0x80000000
    s_cselect_b32 s97, s97, 0x80000000
    s_cselect_b32 s98, s98, 0x80000000
    s_cselect_b32 s99, s99, 0x80000000
    s_mul_i32 s70, s2, 3
    s_add_u32 s70, s70, s33
    s_mul_i32 s71, s70, 886
    s_lshr_b32 s71, s71, 16
    s_mul_i32 s72, s71, 74
    s_sub_u32 s72, s70, s72
    s_mul_i32 s67, s72, 10
    s_add_u32 s67, s67, s71
    s_lshl_b32 s67, s67, 12
    s_add_u32 s67, s67, 0x1100000
    s_mov_b32 s26, 0xc8000
    s_mov_b32 s27, 0x20000
    s_sub_u32 s73, s72, 54
    s_cselect_b32 s72, s72, s73
    s_cselect_b32 s24, s30, s28
    s_cselect_b32 s25, s31, s29
    s_cselect_b32 s26, 0x21c000, s26
    s_mul_i32 s72, s72, 40960
    s_lshl_b32 s71, s71, 7
    s_add_u32 s66, s72, s71
    s_lshl_b32 s68, s2, 5
    s_add_u32 s68, s68, s33
    s_lshl_b32 s68, s68, 2
    s_add_u32 s68, s68, 0x38000
    s_min_u32 s69, s33, 2
    s_lshl_b32 s69, s69, 12
    s_add_u32 s69, s69, 147456
    s_cmp_lt_u32 s33, 3
    s_cselect_b32 s70, s70, 0x7fff
    s_cmp_lt_u32 s70, 740
    s_cselect_b32 s66, s66, 0x80000000
    s_cselect_b32 s67, s67, 0x80000000
    s_cselect_b32 s68, s68, 0x80000000
    s_cselect_b64 s[78:79], -1, 0
    s_lshl1_add_u32 s73, s37, s35
    s_mul_i32 s70, s36, 30
    s_add_u32 s70, s70, s73
    s_lshl_b32 s70, s70, 14
    s_add_u32 s70, s70, 0x40000
    s_cmp_lt_u32 s37, 15
    s_cselect_b32 s58, s70, 0x80000000
    s_cmp_lt_u32 s73, 10
    s_cselect_b32 s64, 0x3ea52b5c, 1.0
    s_lshl_b32 s70, s36, 5
    s_add_u32 s71, s70, s73
    s_lshl_b32 s71, s71, 5
    s_add_u32 s71, s71, s34
    s_lshl_b32 s71, s71, 2
    s_add_u32 s61, s71, 0x1000
    s_add_u32 s71, s70, s37
    s_lshl_b32 s71, s71, 5
    s_add_u32 s71, s71, s33
    s_lshl_b32 s71, s71, 2
    s_add_u32 s62, s71, 0x11000
    s_mul_i32 s70, s36, 37
    s_add_u32 s70, s70, s37
    s_lshl_b32 s70, s70, 14
    s_add_u32 s59, s70, 0x7c0000
    s_lshl_b32 s52, s52, 6
    s_lshl_b32 s53, s53, 6
    s_lshl_b32 s54, s54, 6
    s_lshl_b32 s55, s55, 6
    s_and_b32 s70, s34, 1
    s_lshl1_add_u32 s70, s35, s70
    s_lshl_b32 s56, s70, 6
    s_xor_b32 s57, s56, 64
    v_lshrrev_b32 v128, 5, v138
    v_lshlrev_b32 v128, 11, v128
    v_and_b32 v129, 31, v138
    v_lshl_add_u32 v128, v129, 4, v128
    s_lshl_b32 s70, s34, 9
    v_add_u32 v252, s70, v128
    v_lshlrev_b32 v128, 2, v138
    v_add_u32 v128, 162816, v128
    v_mov_b32 v129, 0
    ds_write_b32 v128, v129
    ds_write_b32 v128, v129 offset:512
    s_lshr_b32 s70, s34, 1
    s_and_b32 s71, s34, 1
    v_lshrrev_b32 v128, 2, v138
    v_min_u32 v128, 2, v128
    v_add_u32 v128, s36, v128
    v_max_u32 v128, 2, v128
    v_subrev_u32 v128, 2, v128
    s_mul_i32 s63, s38, 5
    v_and_b32 v129, 2, v138
    v_lshl_add_u32 v129, v129, 1, s63
    v_lshrrev_b32 v129, 3, v129
    v_lshl_add_u32 v128, v128, 5, v129
    s_mul_i32 s72, s70, 10
    s_add_u32 s72, s72, 10
    v_mov_b32 v129, s72
    v_cmp_gt_u32 vcc, 12, v138
    s_nop 1
    v_cndmask_b32 v129, 0, v129, vcc
    v_add_u32 v128, v129, v128
    v_and_b32 v129, 1, v138
    v_lshl_add_u32 v128, v128, 5, v129
    s_lshl_b32 s72, s71, 3
    s_add_u32 s72, s72, 0x1000
    v_lshl_add_u32 v240, v128, 2, s72
    s_mul_i32 s72, s36, 240
    s_add_u32 s63, s63, s72
    s_mul_i32 s72, s70, 80
    s_add_u32 s63, s63, s72
    s_lshl1_add_u32 s63, s63, s71
    s_lshl_b32 s63, s63, 10
    s_add_u32 s63, s63, 0x68000
    s_mov_b32 s3, 98304
    s_mov_b32 s60, 6272
    s_cmp_eq_u32 s70, 0
    s_cselect_b32 s3, 49152, s3
    s_cselect_b32 s60, 6144, s60
    s_lshl_b32 s71, s71, 10
    s_add_u32 s3, s3, s71
    s_lshr_b32 s83, s2, 3
    s_and_b32 s85, s83, 3
    s_and_b32 s82, s2, 7
    s_lshl_b32 s82, s82, 2
    s_add_u32 s82, s82, s85
    s_lshr_b32 s83, s83, 2
    s_lshr_b32 s84, s82, 1
    s_and_b32 s85, s82, 1
    s_mul_i32 s70, s34, 6
    s_min_u32 s70, s70, 17
    s_add_u32 s89, s70, 32
    s_lshr_b32 s71, s34, 1
    s_sub_u32 s71, 5, s71
    v_min_u32 v130, 37, v138
    v_lshrrev_b32 v131, 1, v130
    s_lshl_b32 s72, s34, 3
    v_add_u32 v128, s72, v131
    v_subrev_u32 v129, 8, v131
    v_min_u32 v129, s71, v129
    v_add_u32 v129, s89, v129
    v_cmp_lt_u32 vcc, 7, v131
    s_nop 1
    v_cndmask_b32 v128, v128, v129, vcc
    s_mul_i32 s72, s34, 5
    s_add_u32 s72, s72, 40
    v_add_u32 v129, s72, v131
    v_cmp_lt_u32 vcc, 13, v131
    s_nop 1
    v_cndmask_b32 v128, v128, v129, vcc
    s_mul_i32 s72, s83, 5
    s_lshr_b32 s72, s72, 2
    v_and_b32 v130, 1, v130
    v_add_u32 v130, s72, v130
    v_mul_u32_u24 v130, 74, v130
    v_add_u32 v130, v130, v128
    v_mul_u32_u24 v131, 0x5556, v130
    v_lshrrev_b32 v131, 16, v131
    v_mul_u32_u24 v128, 29, v131
    v_add_u32 v130, v130, v128
    v_lshlrev_b32 v130, 2, v130
    v_add_u32 v155, 0x38000, v130
    v_subrev_u32 v128, 38, v138
    s_lshl_b32 s46, s34, 3
    v_lshrrev_b32 v129, 1, v128
    v_min_u32 v129, 7, v129
    v_add_u32 v129, s46, v129
    v_lshrrev_b32 v130, 1, v129
    s_lshl_b32 s48, s84, 5
    v_add_u32 v130, s48, v130
    v_lshlrev_b32 v130, 7, v130
    v_and_b32 v129, 1, v129
    v_lshl_add_u32 v130, v129, 4, v130
    v_and_b32 v129, 1, v128
    v_lshl_add_u32 v130, v129, 2, v130
    s_lshl_b32 s48, s85, 3
    s_add_u32 s48, s48, 0x11000
    v_add_u32 v131, s48, v130
    v_cmp_lt_u32 vcc, 37, v138
    s_nop 1
    v_cndmask_b32 v239, v155, v131, vcc
    s_mul_i32 s86, s83, 5120
    s_add_u32 s86, s86, 0x1100000
    s_mul_i32 s87, s84, 606208
    s_lshl_b32 s72, s85, 10
    s_add_u32 s87, s87, s72
    s_add_u32 s87, s87, 0x7c0000
    s_barrier
    s_waitcnt vmcnt(4)
    v_readfirstlane_b32 s32, v139
    v_dot2_f32_bf16 v120, v140, v228, 0
    v_dot2_f32_bf16 v121, v140, v140, 0
    v_dot2_f32_bf16 v120, v141, v228, v120
    v_dot2_f32_bf16 v121, v141, v141, v121
    v_dot2_f32_bf16 v120, v142, v228, v120
    v_dot2_f32_bf16 v121, v142, v142, v121
    v_dot2_f32_bf16 v120, v143, v228, v120
    v_dot2_f32_bf16 v121, v143, v143, v121
    v_dot2_f32_bf16 v120, v144, v228, v120
    v_dot2_f32_bf16 v121, v144, v144, v121
    v_dot2_f32_bf16 v120, v145, v228, v120
    v_dot2_f32_bf16 v121, v145, v145, v121
    v_dot2_f32_bf16 v120, v146, v228, v120
    v_dot2_f32_bf16 v121, v146, v146, v121
    v_dot2_f32_bf16 v120, v147, v228, v120
    v_dot2_f32_bf16 v121, v147, v147, v121
    s_add_u32 s32, s32, 0x9e3779b9
    s_nop 1
    v_add_f32_dpp v120, v120, v120 row_shr:1 row_mask:0xf bank_mask:0xf bound_ctrl:1
    v_add_f32_dpp v121, v121, v121 row_shr:1 row_mask:0xf bank_mask:0xf bound_ctrl:1
    s_nop 0
    v_add_f32_dpp v120, v120, v120 row_shr:2 row_mask:0xf bank_mask:0xf bound_ctrl:1
    v_add_f32_dpp v121, v121, v121 row_shr:2 row_mask:0xf bank_mask:0xf bound_ctrl:1
    s_nop 0
    v_add_f32_dpp v120, v120, v120 row_shr:4 row_mask:0xf bank_mask:0xf bound_ctrl:1
    v_add_f32_dpp v121, v121, v121 row_shr:4 row_mask:0xf bank_mask:0xf bound_ctrl:1
    s_nop 0
    v_add_f32_dpp v120, v120, v120 row_shr:8 row_mask:0xf bank_mask:0xf bound_ctrl:1
    v_add_f32_dpp v121, v121, v121 row_shr:8 row_mask:0xf bank_mask:0xf bound_ctrl:1
    s_nop 0
    v_add_f32_dpp v120, v120, v120 row_bcast:15 row_mask:0xa bank_mask:0xf
    v_add_f32_dpp v121, v121, v121 row_bcast:15 row_mask:0xa bank_mask:0xf
    s_nop 0
    v_add_f32_dpp v120, v120, v120 row_bcast:31 row_mask:0xc bank_mask:0xf
    v_add_f32_dpp v121, v121, v121 row_bcast:31 row_mask:0xc bank_mask:0xf
    v_readlane_b32 s51, v120, 63
    v_readlane_b32 s50, v121, 63
    v_mov_b32 v122, 0x3acccccd
    v_mul_f32 v121, s51, v122
    v_mul_f32 v122, s50, v122
    v_fma_f32 v122, -v121, v121, v122
    v_max_f32 v122, 0, v122
    v_cvt_pk_bf16_f32 v124, v121, v122
    v_and_b32 v125, 0xffff0000, v124
    v_lshlrev_b32 v124, 16, v124
    v_add_f32 v125, 0x3727c5ac, v125
    v_cvt_pk_bf16_f32 v125, v125, v125
    v_lshlrev_b32 v125, 16, v125
    v_sqrt_f32 v125, v125
    v_mov_b32 v126, s32
    v_cvt_pk_bf16_f32 v125, v125, v125
    v_mov_b32 v127, s32
    v_lshlrev_b32 v125, 16, v125
    buffer_store_dwordx4 v[124:127], v254, s[16:19], s45 offen sc1
    s_add_u32 m0, s39, 81920
    s_nop 0
    buffer_load_dwordx4 v248, s[4:7], s41 offen lds
    buffer_load_dwordx4 v249, s[4:7], s41 offen offset:1024 lds
    s_cmp_eq_u32 s40, 2
    s_cselect_b32 s46, 0xfffffb80, s43
    s_add_u32 s41, s41, s46
    s_add_u32 m0, s39, 16384
    s_add_u32 s47, s42, 60416
    buffer_load_dwordx4 v250, s[8:11], s42 offen lds
    buffer_load_dwordx4 v250, s[8:11], s47 offen offset:1024 lds
    s_cmp_eq_u32 s40, 2
    s_cselect_b32 s46, 0xffde4000, s44
    s_add_u32 s42, s42, s46
    s_waitcnt vmcnt(5)
    s_barrier
    ds_read_b128 v[0:3], v246 offset:0
    ds_read_b64_tr_b16 v[200:201], v243 offset:0
    ds_read_b64_tr_b16 v[202:203], v243 offset:2048
    ds_read_b128 v[4:7], v246 offset:2048
    ds_read_b64_tr_b16 v[204:205], v244 offset:0
    ds_read_b64_tr_b16 v[206:207], v244 offset:2048
    ds_read_b64_tr_b16 v[208:209], v245 offset:0
    ds_read_b64_tr_b16 v[210:211], v245 offset:2048
    ds_read_b64_tr_b16 v[192:193], v242 offset:0
    ds_read_b64_tr_b16 v[194:195], v242 offset:2048
    ds_read_b128 v[8:11], v247 offset:0
    ds_read_b64_tr_b16 v[196:197], v242 offset:4096
    ds_read_b64_tr_b16 v[198:199], v242 offset:6144
    ds_read_b128 v[12:15], v247 offset:2048
    ds_read_b64_tr_b16 v[212:213], v243 offset:4096
    ds_read_b64_tr_b16 v[214:215], v243 offset:6144
    s_waitcnt lgkmcnt(6)
    v_mfma_f32_16x16x32_bf16 v[160:163], v[192:195], v[0:3], 0
    ds_read_b64_tr_b16 v[216:217], v244 offset:4096
    s_add_u32 m0, s39, 98304
    s_nop 0
    buffer_load_dwordx4 v248, s[4:7], s41 offen lds
    v_mfma_f32_16x16x32_bf16 v[164:167], v[192:195], v[4:7], 0
    ds_read_b64_tr_b16 v[218:219], v244 offset:6144
    v_mfma_f32_16x16x32_bf16 v[168:171], v[200:203], v[0:3], 0
    ds_read_b64_tr_b16 v[220:221], v245 offset:4096
    v_mfma_f32_16x16x32_bf16 v[172:175], v[200:203], v[4:7], 0
    ds_read_b64_tr_b16 v[222:223], v245 offset:6144
    v_mfma_f32_16x16x32_bf16 v[176:179], v[204:207], v[0:3], 0
    buffer_load_dwordx4 v249, s[4:7], s41 offen offset:1024 lds
    s_cmp_eq_u32 s40, 3
    s_cselect_b32 s46, 0xfffffb80, s43
    s_add_u32 s41, s41, s46
    s_add_u32 m0, s39, 32768
    s_add_u32 s47, s42, 60416
    buffer_load_dwordx4 v250, s[8:11], s42 offen lds
    buffer_load_dwordx4 v250, s[8:11], s47 offen offset:1024 lds
    s_cmp_eq_u32 s40, 3
    s_cselect_b32 s46, 0xffde4000, s44
    s_add_u32 s42, s42, s46
    s_waitcnt vmcnt(4)
    s_barrier
    ds_read_b128 v[16:19], v246 offset:16384
    s_add_u32 m0, s39, 114688
    s_nop 0
    buffer_load_dwordx4 v248, s[4:7], s41 offen lds
    v_mfma_f32_16x16x32_bf16 v[180:183], v[204:207], v[4:7], 0
    ds_read_b64_tr_b16 v[200:201], v243 offset:16384
    ds_read_b64_tr_b16 v[202:203], v243 offset:18432
    v_mfma_f32_16x16x32_bf16 v[184:187], v[208:211], v[0:3], 0
    ds_read_b128 v[20:23], v246 offset:18432
    ds_read_b64_tr_b16 v[204:205], v244 offset:16384
    v_mfma_f32_16x16x32_bf16 v[188:191], v[208:211], v[4:7], 0
    ds_read_b64_tr_b16 v[206:207], v244 offset:18432
    s_waitcnt lgkmcnt(12)
    v_mfma_f32_16x16x32_bf16 v[160:163], v[196:199], v[8:11], v[160:163]
    ds_read_b64_tr_b16 v[208:209], v245 offset:16384
    buffer_load_dwordx4 v249, s[4:7], s41 offen offset:1024 lds
    v_mfma_f32_16x16x32_bf16 v[164:167], v[196:199], v[12:15], v[164:167]
    ds_read_b64_tr_b16 v[210:211], v245 offset:18432
    v_smfmac_f32_16x16x64_bf16 v[224:227], v[228:231], v[192:199], v232
    s_waitcnt lgkmcnt(12)
    v_mfma_f32_16x16x32_bf16 v[168:171], v[212:215], v[8:11], v[168:171]
    ds_read_b64_tr_b16 v[192:193], v242 offset:16384
    v_mfma_f32_16x16x32_bf16 v[172:175], v[212:215], v[12:15], v[172:175]
    ds_read_b64_tr_b16 v[194:195], v242 offset:18432
    s_cmp_eq_u32 s40, 4
    s_cselect_b32 s46, 0xfffffb80, s43
    s_add_u32 s41, s41, s46
    s_add_u32 m0, s39, 49152
    s_add_u32 s47, s42, 60416
    buffer_load_dwordx4 v250, s[8:11], s42 offen lds
    s_waitcnt lgkmcnt(12)
    v_mfma_f32_16x16x32_bf16 v[176:179], v[216:219], v[8:11], v[176:179]
    ds_read_b128 v[24:27], v247 offset:16384
    ds_read_b64_tr_b16 v[196:197], v242 offset:20480
    v_mfma_f32_16x16x32_bf16 v[180:183], v[216:219], v[12:15], v[180:183]
    ds_read_b64_tr_b16 v[198:199], v242 offset:22528
    s_waitcnt lgkmcnt(13)
    v_mfma_f32_16x16x32_bf16 v[184:187], v[220:223], v[8:11], v[184:187]
    ds_read_b128 v[28:31], v247 offset:18432
    ds_read_b64_tr_b16 v[212:213], v243 offset:20480
    v_mfma_f32_16x16x32_bf16 v[188:191], v[220:223], v[12:15], v[188:191]
    ds_read_b64_tr_b16 v[214:215], v243 offset:22528
    buffer_load_dwordx4 v250, s[8:11], s47 offen offset:1024 lds
    s_waitcnt lgkmcnt(6)
    v_mfma_f32_16x16x32_bf16 v[160:163], v[192:195], v[16:19], v[160:163]
    ds_read_b64_tr_b16 v[216:217], v244 offset:20480
    v_mfma_f32_16x16x32_bf16 v[164:167], v[192:195], v[20:23], v[164:167]
    ds_read_b64_tr_b16 v[218:219], v244 offset:22528
    v_mfma_f32_16x16x32_bf16 v[168:171], v[200:203], v[16:19], v[168:171]
    ds_read_b64_tr_b16 v[220:221], v245 offset:20480
    v_mfma_f32_16x16x32_bf16 v[172:175], v[200:203], v[20:23], v[172:175]
    ds_read_b64_tr_b16 v[222:223], v245 offset:22528
    s_cmp_eq_u32 s40, 4
    s_cselect_b32 s46, 0xffde4000, s44
    s_add_u32 s42, s42, s46
    v_mfma_f32_16x16x32_bf16 v[176:179], v[204:207], v[16:19], v[176:179]
    s_waitcnt vmcnt(4)
    s_barrier
    ds_read_b128 v[32:35], v246 offset:32768
    s_add_u32 m0, s39, 65536
    s_nop 0
    buffer_load_dwordx4 v248, s[4:7], s41 offen lds
    v_mfma_f32_16x16x32_bf16 v[180:183], v[204:207], v[20:23], v[180:183]
    ds_read_b64_tr_b16 v[200:201], v243 offset:32768
    ds_read_b64_tr_b16 v[202:203], v243 offset:34816
    v_mfma_f32_16x16x32_bf16 v[184:187], v[208:211], v[16:19], v[184:187]
    ds_read_b128 v[36:39], v246 offset:34816
    ds_read_b64_tr_b16 v[204:205], v244 offset:32768
    buffer_load_dwordx4 v249, s[4:7], s41 offen offset:1024 lds
    v_mfma_f32_16x16x32_bf16 v[188:191], v[208:211], v[20:23], v[188:191]
    ds_read_b64_tr_b16 v[206:207], v244 offset:34816
    s_waitcnt lgkmcnt(12)
    v_mfma_f32_16x16x32_bf16 v[160:163], v[196:199], v[24:27], v[160:163]
    ds_read_b64_tr_b16 v[208:209], v245 offset:32768
    s_cmp_eq_u32 s40, 5
    s_cselect_b32 s46, 0xfffffb80, s43
    s_add_u32 s41, s41, s46
    s_add_u32 m0, s39, 0
    s_add_u32 s47, s42, 60416
    buffer_load_dwordx4 v250, s[8:11], s42 offen lds
    v_mfma_f32_16x16x32_bf16 v[164:167], v[196:199], v[28:31], v[164:167]
    ds_read_b64_tr_b16 v[210:211], v245 offset:34816
    v_smfmac_f32_16x16x64_bf16 v[224:227], v[228:231], v[192:199], v232
    buffer_load_dwordx4 v250, s[8:11], s47 offen offset:1024 lds
    s_waitcnt lgkmcnt(12)
    v_mfma_f32_16x16x32_bf16 v[168:171], v[212:215], v[24:27], v[168:171]
    ds_read_b64_tr_b16 v[192:193], v242 offset:32768
    v_mfma_f32_16x16x32_bf16 v[172:175], v[212:215], v[28:31], v[172:175]
    ds_read_b64_tr_b16 v[194:195], v242 offset:34816
    s_cmp_eq_u32 s40, 5
    s_cselect_b32 s46, 0xffde4000, s44
    s_add_u32 s42, s42, s46
    s_mov_b32 m0, s69
    s_add_u32 s47, s66, 0
    s_mov_b64 exec, s[78:79]
    buffer_load_dwordx4 v241, s[24:27], s47 offen offset:0 lds
    s_mov_b64 exec, -1
    s_waitcnt lgkmcnt(12)
    v_mfma_f32_16x16x32_bf16 v[176:179], v[216:219], v[24:27], v[176:179]
    ds_read_b128 v[40:43], v247 offset:32768
    ds_read_b64_tr_b16 v[196:197], v242 offset:36864
    v_mfma_f32_16x16x32_bf16 v[180:183], v[216:219], v[28:31], v[180:183]
    ds_read_b64_tr_b16 v[198:199], v242 offset:38912
    s_add_u32 s47, s66, 19456
    s_mov_b64 exec, s[78:79]
    buffer_load_dwordx4 v241, s[24:27], s47 offen offset:1024 lds
    s_mov_b64 exec, -1
    s_waitcnt lgkmcnt(13)
    v_mfma_f32_16x16x32_bf16 v[184:187], v[220:223], v[24:27], v[184:187]
    ds_read_b128 v[44:47], v247 offset:34816
    ds_read_b64_tr_b16 v[212:213], v243 offset:36864
    v_mfma_f32_16x16x32_bf16 v[188:191], v[220:223], v[28:31], v[188:191]
    ds_read_b64_tr_b16 v[214:215], v243 offset:38912
    s_add_u32 s47, s66, 3072
    s_mov_b64 exec, s[78:79]
    buffer_load_dwordx4 v241, s[24:27], s47 offen offset:2048 lds
    s_mov_b64 exec, -1
    s_waitcnt lgkmcnt(6)
    v_mfma_f32_16x16x32_bf16 v[160:163], v[192:195], v[32:35], v[160:163]
    ds_read_b64_tr_b16 v[216:217], v244 offset:36864
    v_mfma_f32_16x16x32_bf16 v[164:167], v[192:195], v[36:39], v[164:167]
    ds_read_b64_tr_b16 v[218:219], v244 offset:38912
    s_add_u32 s47, s66, 22528
    s_mov_b64 exec, s[78:79]
    buffer_load_dwordx4 v241, s[24:27], s47 offen offset:3072 lds
    s_mov_b64 exec, -1
    v_mfma_f32_16x16x32_bf16 v[168:171], v[200:203], v[32:35], v[168:171]
    ds_read_b64_tr_b16 v[220:221], v245 offset:36864
    v_mfma_f32_16x16x32_bf16 v[172:175], v[200:203], v[36:39], v[172:175]
    ds_read_b64_tr_b16 v[222:223], v245 offset:38912
    v_mov_b32 v241, v239
    v_mfma_f32_16x16x32_bf16 v[176:179], v[204:207], v[32:35], v[176:179]
    s_waitcnt vmcnt(8)
    s_barrier
    ds_read_b128 v[48:51], v246 offset:49152
    s_add_u32 m0, s39, 81920
    s_nop 0
    buffer_load_dwordx4 v248, s[4:7], s41 offen lds
    v_mfma_f32_16x16x32_bf16 v[180:183], v[204:207], v[36:39], v[180:183]
    ds_read_b64_tr_b16 v[200:201], v243 offset:49152
    ds_read_b64_tr_b16 v[202:203], v243 offset:51200
    v_mfma_f32_16x16x32_bf16 v[184:187], v[208:211], v[32:35], v[184:187]
    ds_read_b128 v[52:55], v246 offset:51200
    ds_read_b64_tr_b16 v[204:205], v244 offset:49152
    v_mfma_f32_16x16x32_bf16 v[188:191], v[208:211], v[36:39], v[188:191]
    ds_read_b64_tr_b16 v[206:207], v244 offset:51200
    s_waitcnt lgkmcnt(12)
    v_mfma_f32_16x16x32_bf16 v[160:163], v[196:199], v[40:43], v[160:163]
    ds_read_b64_tr_b16 v[208:209], v245 offset:49152
    buffer_load_dwordx4 v249, s[4:7], s41 offen offset:1024 lds
    v_mfma_f32_16x16x32_bf16 v[164:167], v[196:199], v[44:47], v[164:167]
    ds_read_b64_tr_b16 v[210:211], v245 offset:51200
    v_smfmac_f32_16x16x64_bf16 v[224:227], v[228:231], v[192:199], v232
    s_waitcnt lgkmcnt(12)
    v_mfma_f32_16x16x32_bf16 v[168:171], v[212:215], v[40:43], v[168:171]
    ds_read_b64_tr_b16 v[192:193], v242 offset:49152
    v_mfma_f32_16x16x32_bf16 v[172:175], v[212:215], v[44:47], v[172:175]
    ds_read_b64_tr_b16 v[194:195], v242 offset:51200
    s_cmp_eq_u32 s40, 6
    s_cselect_b32 s46, 0xfffffb80, s43
    s_add_u32 s41, s41, s46
    s_add_u32 m0, s39, 16384
    s_add_u32 s47, s42, 60416
    buffer_load_dwordx4 v250, s[8:11], s42 offen lds
    s_waitcnt lgkmcnt(12)
    v_mfma_f32_16x16x32_bf16 v[176:179], v[216:219], v[40:43], v[176:179]
    ds_read_b128 v[56:59], v247 offset:49152
    ds_read_b64_tr_b16 v[196:197], v242 offset:53248
    v_mfma_f32_16x16x32_bf16 v[180:183], v[216:219], v[44:47], v[180:183]
    ds_read_b64_tr_b16 v[198:199], v242 offset:55296
    s_waitcnt lgkmcnt(13)
    v_mfma_f32_16x16x32_bf16 v[184:187], v[220:223], v[40:43], v[184:187]
    ds_read_b128 v[60:63], v247 offset:51200
    ds_read_b64_tr_b16 v[212:213], v243 offset:53248
    v_mfma_f32_16x16x32_bf16 v[188:191], v[220:223], v[44:47], v[188:191]
    ds_read_b64_tr_b16 v[214:215], v243 offset:55296
    buffer_load_dwordx4 v250, s[8:11], s47 offen offset:1024 lds
    s_waitcnt lgkmcnt(6)
    v_mfma_f32_16x16x32_bf16 v[160:163], v[192:195], v[48:51], v[160:163]
    ds_read_b64_tr_b16 v[216:217], v244 offset:53248
    v_mfma_f32_16x16x32_bf16 v[164:167], v[192:195], v[52:55], v[164:167]
    ds_read_b64_tr_b16 v[218:219], v244 offset:55296
    v_mfma_f32_16x16x32_bf16 v[168:171], v[200:203], v[48:51], v[168:171]
    ds_read_b64_tr_b16 v[220:221], v245 offset:53248
    v_mfma_f32_16x16x32_bf16 v[172:175], v[200:203], v[52:55], v[172:175]
    ds_read_b64_tr_b16 v[222:223], v245 offset:55296
    s_cmp_eq_u32 s40, 6
    s_cselect_b32 s46, 0xffde4000, s44
    s_add_u32 s42, s42, s46
    v_mfma_f32_16x16x32_bf16 v[176:179], v[204:207], v[48:51], v[176:179]
    s_waitcnt vmcnt(8)
    s_barrier
    ds_read_b128 v[64:67], v246 offset:0
    s_add_u32 m0, s39, 98304
    s_nop 0
    buffer_load_dwordx4 v248, s[4:7], s41 offen lds
    v_mfma_f32_16x16x32_bf16 v[180:183], v[204:207], v[52:55], v[180:183]
    ds_read_b64_tr_b16 v[200:201], v243 offset:0
    ds_read_b64_tr_b16 v[202:203], v243 offset:2048
    v_mfma_f32_16x16x32_bf16 v[184:187], v[208:211], v[48:51], v[184:187]
    ds_read_b128 v[68:71], v246 offset:2048
    ds_read_b64_tr_b16 v[204:205], v244 offset:0
    v_mfma_f32_16x16x32_bf16 v[188:191], v[208:211], v[52:55], v[188:191]
    ds_read_b64_tr_b16 v[206:207], v244 offset:2048
    s_waitcnt lgkmcnt(12)
    v_mfma_f32_16x16x32_bf16 v[160:163], v[196:199], v[56:59], v[160:163]
    ds_read_b64_tr_b16 v[208:209], v245 offset:0
    buffer_load_dwordx4 v249, s[4:7], s41 offen offset:1024 lds
    v_mfma_f32_16x16x32_bf16 v[164:167], v[196:199], v[60:63], v[164:167]
    ds_read_b64_tr_b16 v[210:211], v245 offset:2048
    v_smfmac_f32_16x16x64_bf16 v[224:227], v[228:231], v[192:199], v232
    s_waitcnt lgkmcnt(12)
    v_mfma_f32_16x16x32_bf16 v[168:171], v[212:215], v[56:59], v[168:171]
    ds_read_b64_tr_b16 v[192:193], v242 offset:0
    v_mfma_f32_16x16x32_bf16 v[172:175], v[212:215], v[60:63], v[172:175]
    ds_read_b64_tr_b16 v[194:195], v242 offset:2048
    s_cmp_eq_u32 s40, 7
    s_cselect_b32 s46, 0xfffffb80, s43
    s_add_u32 s41, s41, s46
    s_add_u32 m0, s39, 32768
    s_add_u32 s47, s42, 60416
    buffer_load_dwordx4 v250, s[8:11], s42 offen lds
    s_waitcnt lgkmcnt(12)
    v_mfma_f32_16x16x32_bf16 v[176:179], v[216:219], v[56:59], v[176:179]
    ds_read_b128 v[72:75], v247 offset:0
    ds_read_b64_tr_b16 v[196:197], v242 offset:4096
    v_mfma_f32_16x16x32_bf16 v[180:183], v[216:219], v[60:63], v[180:183]
    ds_read_b64_tr_b16 v[198:199], v242 offset:6144
    s_waitcnt lgkmcnt(13)
    v_mfma_f32_16x16x32_bf16 v[184:187], v[220:223], v[56:59], v[184:187]
    ds_read_b128 v[76:79], v247 offset:2048
    ds_read_b64_tr_b16 v[212:213], v243 offset:4096
    v_mfma_f32_16x16x32_bf16 v[188:191], v[220:223], v[60:63], v[188:191]
    ds_read_b64_tr_b16 v[214:215], v243 offset:6144
    buffer_load_dwordx4 v250, s[8:11], s47 offen offset:1024 lds
    s_waitcnt lgkmcnt(6)
    v_mfma_f32_16x16x32_bf16 v[160:163], v[192:195], v[64:67], v[160:163]
    ds_read_b64_tr_b16 v[216:217], v244 offset:4096
    v_mfma_f32_16x16x32_bf16 v[164:167], v[192:195], v[68:71], v[164:167]
    ds_read_b64_tr_b16 v[218:219], v244 offset:6144
    v_mfma_f32_16x16x32_bf16 v[168:171], v[200:203], v[64:67], v[168:171]
    ds_read_b64_tr_b16 v[220:221], v245 offset:4096
    v_mfma_f32_16x16x32_bf16 v[172:175], v[200:203], v[68:71], v[172:175]
    ds_read_b64_tr_b16 v[222:223], v245 offset:6144
    s_cmp_eq_u32 s40, 7
    s_cselect_b32 s46, 0xffde4000, s44
    s_add_u32 s42, s42, s46
    v_mfma_f32_16x16x32_bf16 v[176:179], v[204:207], v[64:67], v[176:179]
    s_waitcnt vmcnt(4)
    s_barrier
    ds_read_b128 v[80:83], v246 offset:16384
    s_add_u32 m0, s39, 114688
    s_nop 0
    buffer_load_dwordx4 v248, s[4:7], s41 offen lds
    v_mfma_f32_16x16x32_bf16 v[180:183], v[204:207], v[68:71], v[180:183]
    ds_read_b64_tr_b16 v[200:201], v243 offset:16384
    ds_read_b64_tr_b16 v[202:203], v243 offset:18432
    s_lshr_b32 s70, s52, 1
    v_mfma_f32_16x16x32_bf16 v[184:187], v[208:211], v[64:67], v[184:187]
    ds_read_b128 v[84:87], v246 offset:18432
    ds_read_b64_tr_b16 v[204:205], v244 offset:16384
    v_and_b32 v148, 0xfff, v242
    v_xor_b32 v148, s70, v148
    v_mfma_f32_16x16x32_bf16 v[188:191], v[208:211], v[68:71], v[188:191]
    ds_read_b64_tr_b16 v[206:207], v244 offset:18432
    v_add_u32 v148, s69, v148
    v_lshlrev_b32 v150, 4, v138
    s_waitcnt lgkmcnt(12)
    v_mfma_f32_16x16x32_bf16 v[160:163], v[196:199], v[72:75], v[160:163]
    ds_read_b64_tr_b16 v[208:209], v245 offset:16384
    buffer_load_dwordx4 v249, s[4:7], s41 offen offset:1024 lds
    v_xor_b32 v151, 0, v148
    v_mfma_f32_16x16x32_bf16 v[164:167], v[196:199], v[76:79], v[164:167]
    ds_read_b64_tr_b16 v[210:211], v245 offset:18432
    ds_read_b64_tr_b16 v[128:129], v151
    ds_read_b64_tr_b16 v[130:131], v151 offset:2048
    v_xor_b32 v151, 32, v148
    v_smfmac_f32_16x16x64_bf16 v[224:227], v[228:231], v[192:199], v232
    ds_read_b64_tr_b16 v[132:133], v151
    ds_read_b64_tr_b16 v[134:135], v151 offset:2048
    v_xor_b32 v151, 64, v148
    s_waitcnt lgkmcnt(15)
    v_mfma_f32_16x16x32_bf16 v[168:171], v[212:215], v[72:75], v[168:171]
    ds_read_b64_tr_b16 v[192:193], v242 offset:16384
    ds_read_b64_tr_b16 v[140:141], v151
    ds_read_b64_tr_b16 v[142:143], v151 offset:2048
    v_xor_b32 v151, 96, v148
    v_mfma_f32_16x16x32_bf16 v[172:175], v[212:215], v[76:79], v[172:175]
    ds_read_b64_tr_b16 v[194:195], v242 offset:18432
    s_cmp_eq_u32 s40, 8
    s_cselect_b32 s46, 0xfffffb80, s43
    s_add_u32 s41, s41, s46
    s_add_u32 m0, s39, 49152
    s_add_u32 s47, s42, 60416
    buffer_load_dwordx4 v250, s[8:11], s42 offen lds
    s_waitcnt lgkmcnt(15)
    v_mfma_f32_16x16x32_bf16 v[176:179], v[216:219], v[72:75], v[176:179]
    ds_read_b128 v[88:91], v247 offset:16384
    ds_read_b64_tr_b16 v[196:197], v242 offset:20480
    ds_read_b64_tr_b16 v[144:145], v151
    ds_read_b64_tr_b16 v[146:147], v151 offset:2048
    v_mfma_f32_16x16x32_bf16 v[180:183], v[216:219], v[76:79], v[180:183]
    ds_read_b64_tr_b16 v[198:199], v242 offset:22528
    v_mfma_f32_16x16x32_bf16 v[184:187], v[220:223], v[72:75], v[184:187]
    ds_read_b128 v[92:95], v247 offset:18432
    ds_read_b64_tr_b16 v[212:213], v243 offset:20480
    v_mfma_f32_16x16x32_bf16 v[188:191], v[220:223], v[76:79], v[188:191]
    ds_read_b64_tr_b16 v[214:215], v243 offset:22528
    buffer_load_dwordx4 v250, s[8:11], s47 offen offset:1024 lds
    s_waitcnt lgkmcnt(8)
    v_mfma_f32_16x16x32_bf16 v[160:163], v[192:195], v[80:83], v[160:163]
    ds_read_b64_tr_b16 v[216:217], v244 offset:20480
    s_waitcnt lgkmcnt(4)
    s_mov_b64 exec, s[78:79]
    buffer_store_dwordx4 v[128:131], v150, s[16:19], s67 offen offset:0 sc1
    s_mov_b64 exec, -1
    v_mfma_f32_16x16x32_bf16 v[164:167], v[192:195], v[84:87], v[164:167]
    ds_read_b64_tr_b16 v[218:219], v244 offset:22528
    v_mfma_f32_16x16x32_bf16 v[168:171], v[200:203], v[80:83], v[168:171]
    ds_read_b64_tr_b16 v[220:221], v245 offset:20480
    s_mov_b64 exec, s[78:79]
    buffer_store_dwordx4 v[132:135], v150, s[16:19], s67 offen offset:1024 sc1
    s_mov_b64 exec, -1
    v_mfma_f32_16x16x32_bf16 v[172:175], v[200:203], v[84:87], v[172:175]
    ds_read_b64_tr_b16 v[222:223], v245 offset:22528
    s_cmp_eq_u32 s40, 8
    s_cselect_b32 s46, 0xffde4000, s44
    s_add_u32 s42, s42, s46
    v_mfma_f32_16x16x32_bf16 v[176:179], v[204:207], v[80:83], v[176:179]
    s_waitcnt vmcnt(6)
    s_barrier
    ds_read_b128 v[96:99], v246 offset:32768
    s_add_u32 m0, s39, 65536
    s_nop 0
    buffer_load_dwordx4 v248, s[4:7], s41 offen lds
    v_mfma_f32_16x16x32_bf16 v[180:183], v[204:207], v[84:87], v[180:183]
    ds_read_b64_tr_b16 v[200:201], v243 offset:32768
    ds_read_b64_tr_b16 v[202:203], v243 offset:34816
    v_mfma_f32_16x16x32_bf16 v[184:187], v[208:211], v[80:83], v[184:187]
    ds_read_b128 v[100:103], v246 offset:34816
    ds_read_b64_tr_b16 v[204:205], v244 offset:32768
    s_mov_b64 exec, s[78:79]
    buffer_store_dwordx4 v[140:143], v150, s[16:19], s67 offen offset:2048 sc1
    s_mov_b64 exec, -1
    v_mfma_f32_16x16x32_bf16 v[188:191], v[208:211], v[84:87], v[188:191]
    ds_read_b64_tr_b16 v[206:207], v244 offset:34816
    s_waitcnt lgkmcnt(12)
    v_mfma_f32_16x16x32_bf16 v[160:163], v[196:199], v[88:91], v[160:163]
    ds_read_b64_tr_b16 v[208:209], v245 offset:32768
    buffer_load_dwordx4 v249, s[4:7], s41 offen offset:1024 lds
    s_mov_b64 exec, s[78:79]
    buffer_store_dwordx4 v[144:147], v150, s[16:19], s67 offen offset:3072 sc1
    s_mov_b64 exec, -1
    v_mfma_f32_16x16x32_bf16 v[164:167], v[196:199], v[92:95], v[164:167]
    ds_read_b64_tr_b16 v[210:211], v245 offset:34816
    v_smfmac_f32_16x16x64_bf16 v[224:227], v[228:231], v[192:199], v232
    s_waitcnt lgkmcnt(12)
    v_mfma_f32_16x16x32_bf16 v[168:171], v[212:215], v[88:91], v[168:171]
    ds_read_b64_tr_b16 v[192:193], v242 offset:32768
    v_mfma_f32_16x16x32_bf16 v[172:175], v[212:215], v[92:95], v[172:175]
    ds_read_b64_tr_b16 v[194:195], v242 offset:34816
    s_cmp_eq_u32 s40, 9
    s_cselect_b32 s46, 0xfffffb80, s43
    s_add_u32 s41, s41, s46
    s_add_u32 m0, s39, 0
    s_add_u32 s47, s42, 60416
    buffer_load_dwordx4 v250, s[8:11], s42 offen lds
    s_waitcnt lgkmcnt(12)
    v_mfma_f32_16x16x32_bf16 v[176:179], v[216:219], v[88:91], v[176:179]
    ds_read_b128 v[104:107], v247 offset:32768
    ds_read_b64_tr_b16 v[196:197], v242 offset:36864
    v_mfma_f32_16x16x32_bf16 v[180:183], v[216:219], v[92:95], v[180:183]
    ds_read_b64_tr_b16 v[198:199], v242 offset:38912
    s_waitcnt lgkmcnt(13)
    v_mfma_f32_16x16x32_bf16 v[184:187], v[220:223], v[88:91], v[184:187]
    ds_read_b128 v[108:111], v247 offset:34816
    ds_read_b64_tr_b16 v[212:213], v243 offset:36864
    v_mfma_f32_16x16x32_bf16 v[188:191], v[220:223], v[92:95], v[188:191]
    ds_read_b64_tr_b16 v[214:215], v243 offset:38912
    buffer_load_dwordx4 v250, s[8:11], s47 offen offset:1024 lds
    s_waitcnt lgkmcnt(6)
    v_mfma_f32_16x16x32_bf16 v[160:163], v[192:195], v[96:99], v[160:163]
    ds_read_b64_tr_b16 v[216:217], v244 offset:36864
    v_mfma_f32_16x16x32_bf16 v[164:167], v[192:195], v[100:103], v[164:167]
    ds_read_b64_tr_b16 v[218:219], v244 offset:38912
    v_mfma_f32_16x16x32_bf16 v[168:171], v[200:203], v[96:99], v[168:171]
    ds_read_b64_tr_b16 v[220:221], v245 offset:36864
    v_mfma_f32_16x16x32_bf16 v[172:175], v[200:203], v[100:103], v[172:175]
    ds_read_b64_tr_b16 v[222:223], v245 offset:38912
    s_cmp_eq_u32 s40, 9
    s_cselect_b32 s46, 0xffde4000, s44
    s_add_u32 s42, s42, s46
    v_mfma_f32_16x16x32_bf16 v[176:179], v[204:207], v[96:99], v[176:179]
    s_waitcnt vmcnt(8)
    s_barrier
    ds_read_b128 v[112:115], v246 offset:49152
    s_add_u32 m0, s39, 81920
    s_nop 0
    buffer_load_dwordx4 v248, s[4:7], s41 offen lds
    v_mfma_f32_16x16x32_bf16 v[180:183], v[204:207], v[100:103], v[180:183]
    ds_read_b64_tr_b16 v[200:201], v243 offset:49152
    ds_read_b64_tr_b16 v[202:203], v243 offset:51200
    v_mfma_f32_16x16x32_bf16 v[184:187], v[208:211], v[96:99], v[184:187]
    ds_read_b128 v[116:119], v246 offset:51200
    ds_read_b64_tr_b16 v[204:205], v244 offset:49152
    v_mfma_f32_16x16x32_bf16 v[188:191], v[208:211], v[100:103], v[188:191]
    ds_read_b64_tr_b16 v[206:207], v244 offset:51200
    s_waitcnt lgkmcnt(12)
    v_mfma_f32_16x16x32_bf16 v[160:163], v[196:199], v[104:107], v[160:163]
    ds_read_b64_tr_b16 v[208:209], v245 offset:49152
    buffer_load_dwordx4 v249, s[4:7], s41 offen offset:1024 lds
    v_mfma_f32_16x16x32_bf16 v[164:167], v[196:199], v[108:111], v[164:167]
    ds_read_b64_tr_b16 v[210:211], v245 offset:51200
    v_smfmac_f32_16x16x64_bf16 v[224:227], v[228:231], v[192:199], v232
    s_waitcnt lgkmcnt(12)
    v_mfma_f32_16x16x32_bf16 v[168:171], v[212:215], v[104:107], v[168:171]
    ds_read_b64_tr_b16 v[192:193], v242 offset:49152
    v_mfma_f32_16x16x32_bf16 v[172:175], v[212:215], v[108:111], v[172:175]
    ds_read_b64_tr_b16 v[194:195], v242 offset:51200
    s_add_u32 m0, s39, 16384
    s_add_u32 s47, s42, 60416
    buffer_load_dwordx4 v250, s[8:11], s42 offen lds
    s_waitcnt lgkmcnt(12)
    v_mfma_f32_16x16x32_bf16 v[176:179], v[216:219], v[104:107], v[176:179]
    ds_read_b128 v[120:123], v247 offset:49152
    ds_read_b64_tr_b16 v[196:197], v242 offset:53248
    v_mfma_f32_16x16x32_bf16 v[180:183], v[216:219], v[108:111], v[180:183]
    ds_read_b64_tr_b16 v[198:199], v242 offset:55296
    s_waitcnt lgkmcnt(13)
    v_mfma_f32_16x16x32_bf16 v[184:187], v[220:223], v[104:107], v[184:187]
    ds_read_b128 v[124:127], v247 offset:51200
    ds_read_b64_tr_b16 v[212:213], v243 offset:53248
    v_mfma_f32_16x16x32_bf16 v[188:191], v[220:223], v[108:111], v[188:191]
    ds_read_b64_tr_b16 v[214:215], v243 offset:55296
    buffer_load_dwordx4 v250, s[8:11], s47 offen offset:1024 lds
    s_waitcnt lgkmcnt(6)
    v_mfma_f32_16x16x32_bf16 v[160:163], v[192:195], v[112:115], v[160:163]
    ds_read_b64_tr_b16 v[216:217], v244 offset:53248
    v_mfma_f32_16x16x32_bf16 v[164:167], v[192:195], v[116:119], v[164:167]
    ds_read_b64_tr_b16 v[218:219], v244 offset:55296
    v_mfma_f32_16x16x32_bf16 v[168:171], v[200:203], v[112:115], v[168:171]
    ds_read_b64_tr_b16 v[220:221], v245 offset:53248
    v_mfma_f32_16x16x32_bf16 v[172:175], v[200:203], v[116:119], v[172:175]
    ds_read_b64_tr_b16 v[222:223], v245 offset:55296
    s_lshl_b32 s51, s36, 2
    s_add_u32 s51, s51, s34
    s_lshl_b32 s51, s51, 9
    s_add_u32 s45, s51, 0x30000
    v_and_b32 v255, 0xf0, v252
    buffer_load_dwordx3 v[248:250], v255, s[16:19], s45 offen sc1
    buffer_load_dwordx3 v[236:238], v255, s[16:19], s45 offen offset:256 sc1
    v_mfma_f32_16x16x32_bf16 v[176:179], v[204:207], v[112:115], v[176:179]
    s_waitcnt vmcnt(6)
    s_barrier
    ds_read_b128 v[128:131], v246 offset:0
    s_add_u32 m0, s39, 131072
    s_add_u32 s47, s90, 54272
    buffer_load_dwordx4 v251, s[12:15], s90 offen lds
    v_mfma_f32_16x16x32_bf16 v[180:183], v[204:207], v[116:119], v[180:183]
    ds_read_b64_tr_b16 v[200:201], v243 offset:0
    ds_read_b64_tr_b16 v[202:203], v243 offset:2048
    v_mfma_f32_16x16x32_bf16 v[184:187], v[208:211], v[112:115], v[184:187]
    ds_read_b128 v[132:135], v246 offset:2048
    ds_read_b64_tr_b16 v[204:205], v244 offset:0
    v_mfma_f32_16x16x32_bf16 v[188:191], v[208:211], v[116:119], v[188:191]
    ds_read_b64_tr_b16 v[206:207], v244 offset:2048
    s_waitcnt lgkmcnt(12)
    v_mfma_f32_16x16x32_bf16 v[160:163], v[196:199], v[120:123], v[160:163]
    ds_read_b64_tr_b16 v[208:209], v245 offset:0
    buffer_load_dwordx4 v251, s[12:15], s47 offen offset:1024 lds
    v_mfma_f32_16x16x32_bf16 v[164:167], v[196:199], v[124:127], v[164:167]
    ds_read_b64_tr_b16 v[210:211], v245 offset:2048
    v_smfmac_f32_16x16x64_bf16 v[224:227], v[228:231], v[192:199], v232
    s_waitcnt lgkmcnt(12)
    v_mfma_f32_16x16x32_bf16 v[168:171], v[212:215], v[120:123], v[168:171]
    ds_read_b64_tr_b16 v[192:193], v242 offset:0
    v_mfma_f32_16x16x32_bf16 v[172:175], v[212:215], v[124:127], v[172:175]
    ds_read_b64_tr_b16 v[194:195], v242 offset:2048
    s_add_u32 m0, s39, 32768
    s_add_u32 s47, s95, 54272
    buffer_load_dwordx4 v251, s[12:15], s95 offen lds
    s_waitcnt lgkmcnt(12)
    v_mfma_f32_16x16x32_bf16 v[176:179], v[216:219], v[120:123], v[176:179]
    ds_read_b128 v[136:139], v247 offset:0
    ds_read_b64_tr_b16 v[196:197], v242 offset:4096
    v_mfma_f32_16x16x32_bf16 v[180:183], v[216:219], v[124:127], v[180:183]
    ds_read_b64_tr_b16 v[198:199], v242 offset:6144
    s_waitcnt lgkmcnt(13)
    v_mfma_f32_16x16x32_bf16 v[184:187], v[220:223], v[120:123], v[184:187]
    ds_read_b128 v[140:143], v247 offset:2048
    ds_read_b64_tr_b16 v[212:213], v243 offset:4096
    v_mfma_f32_16x16x32_bf16 v[188:191], v[220:223], v[124:127], v[188:191]
    ds_read_b64_tr_b16 v[214:215], v243 offset:6144
    buffer_load_dwordx4 v251, s[12:15], s47 offen offset:1024 lds
    s_waitcnt lgkmcnt(6)
    v_mfma_f32_16x16x32_bf16 v[160:163], v[192:195], v[128:131], v[160:163]
    ds_read_b64_tr_b16 v[216:217], v244 offset:4096
    v_mfma_f32_16x16x32_bf16 v[164:167], v[192:195], v[132:135], v[164:167]
    ds_read_b64_tr_b16 v[218:219], v244 offset:6144
    v_mfma_f32_16x16x32_bf16 v[168:171], v[200:203], v[128:131], v[168:171]
    ds_read_b64_tr_b16 v[220:221], v245 offset:4096
    v_mfma_f32_16x16x32_bf16 v[172:175], v[200:203], v[132:135], v[172:175]
    ds_read_b64_tr_b16 v[222:223], v245 offset:6144
    v_mfma_f32_16x16x32_bf16 v[176:179], v[204:207], v[128:131], v[176:179]
    s_waitcnt vmcnt(6)
    s_barrier
    v_mov_b32 v255, s32
    buffer_store_dword v255, v254, s[16:19], s68 offen sc1
    ds_read_b128 v[144:147], v246 offset:16384
    v_mfma_f32_16x16x32_bf16 v[180:183], v[204:207], v[132:135], v[180:183]
    ds_read_b64_tr_b16 v[200:201], v243 offset:16384
    ds_read_b64_tr_b16 v[202:203], v243 offset:18432
    v_mfma_f32_16x16x32_bf16 v[184:187], v[208:211], v[128:131], v[184:187]
    ds_read_b128 v[148:151], v246 offset:18432
    ds_read_b64_tr_b16 v[204:205], v244 offset:16384
    v_mfma_f32_16x16x32_bf16 v[188:191], v[208:211], v[132:135], v[188:191]
    ds_read_b64_tr_b16 v[206:207], v244 offset:18432
    s_add_u32 m0, s39, 98304
    s_add_u32 s47, s91, 54272
    buffer_load_dwordx4 v251, s[12:15], s91 offen lds
    s_waitcnt lgkmcnt(12)
    v_mfma_f32_16x16x32_bf16 v[160:163], v[196:199], v[136:139], v[160:163]
    ds_read_b64_tr_b16 v[208:209], v245 offset:16384
    v_mfma_f32_16x16x32_bf16 v[164:167], v[196:199], v[140:143], v[164:167]
    ds_read_b64_tr_b16 v[210:211], v245 offset:18432
    v_smfmac_f32_16x16x64_bf16 v[224:227], v[228:231], v[192:199], v232
    s_waitcnt lgkmcnt(12)
    v_mfma_f32_16x16x32_bf16 v[168:171], v[212:215], v[136:139], v[168:171]
    ds_read_b64_tr_b16 v[192:193], v242 offset:16384
    buffer_load_dwordx4 v251, s[12:15], s47 offen offset:1024 lds
    v_mfma_f32_16x16x32_bf16 v[172:175], v[212:215], v[140:143], v[172:175]
    ds_read_b64_tr_b16 v[194:195], v242 offset:18432
    s_waitcnt lgkmcnt(12)
    v_mfma_f32_16x16x32_bf16 v[176:179], v[216:219], v[136:139], v[176:179]
    ds_read_b128 v[152:155], v247 offset:16384
    ds_read_b64_tr_b16 v[196:197], v242 offset:20480
    v_mfma_f32_16x16x32_bf16 v[180:183], v[216:219], v[140:143], v[180:183]
    ds_read_b64_tr_b16 v[198:199], v242 offset:22528
    s_waitcnt lgkmcnt(13)
    v_mfma_f32_16x16x32_bf16 v[184:187], v[220:223], v[136:139], v[184:187]
    ds_read_b128 v[156:159], v247 offset:18432
    ds_read_b64_tr_b16 v[212:213], v243 offset:20480
    v_mfma_f32_16x16x32_bf16 v[188:191], v[220:223], v[140:143], v[188:191]
    ds_read_b64_tr_b16 v[214:215], v243 offset:22528
    s_waitcnt lgkmcnt(6)
    v_mfma_f32_16x16x32_bf16 v[160:163], v[192:195], v[144:147], v[160:163]
    ds_read_b64_tr_b16 v[216:217], v244 offset:20480
    v_mfma_f32_16x16x32_bf16 v[164:167], v[192:195], v[148:151], v[164:167]
    ds_read_b64_tr_b16 v[218:219], v244 offset:22528
    v_mfma_f32_16x16x32_bf16 v[168:171], v[200:203], v[144:147], v[168:171]
    ds_read_b64_tr_b16 v[220:221], v245 offset:20480
    v_mfma_f32_16x16x32_bf16 v[172:175], v[200:203], v[148:151], v[172:175]
    ds_read_b64_tr_b16 v[222:223], v245 offset:22528
    v_mfma_f32_16x16x32_bf16 v[176:179], v[204:207], v[144:147], v[176:179]
    v_mfma_f32_16x16x32_bf16 v[180:183], v[204:207], v[148:151], v[180:183]
    v_mfma_f32_16x16x32_bf16 v[184:187], v[208:211], v[144:147], v[184:187]
    v_mfma_f32_16x16x32_bf16 v[188:191], v[208:211], v[148:151], v[188:191]
    s_xor_b32 s70, s52, s56
    s_lshr_b32 s70, s70, 1
    v_and_b32 v242, 0xfff, v242
    v_xor_b32 v242, s70, v242
    v_add_u32 v242, 81920, v242
    v_xor_b32 v243, 32, v242
    s_waitcnt lgkmcnt(6)
    v_mfma_f32_16x16x32_bf16 v[160:163], v[196:199], v[152:155], v[160:163]
    v_mfma_f32_16x16x32_bf16 v[164:167], v[196:199], v[156:159], v[164:167]
    v_smfmac_f32_16x16x64_bf16 v[224:227], v[228:231], v[192:199], v232
    s_waitcnt lgkmcnt(4)
    v_mfma_f32_16x16x32_bf16 v[168:171], v[212:215], v[152:155], v[168:171]
    v_mfma_f32_16x16x32_bf16 v[172:175], v[212:215], v[156:159], v[172:175]
    s_waitcnt lgkmcnt(2)
    v_mfma_f32_16x16x32_bf16 v[176:179], v[216:219], v[152:155], v[176:179]
    s_lshl_b32 s51, s35, 8
    s_add_u32 s51, s51, s52
    v_bfe_u32 v255, v252, 4, 4
    s_add_u32 s51, s51, 162304
    v_lshl_add_u32 v255, v255, 2, s51
    v_add_f32 v224, v224, v225
    s_mov_b64 exec, 0xffff
    ds_write_b32 v255, v224
    s_mov_b64 exec, -1
    s_waitcnt vmcnt(5) lgkmcnt(0)
    s_barrier
    v_cmp_ne_u32 vcc, s32, v250
    v_cmp_ne_u32 s[74:75], s32, v238
    s_nop 0
    s_or_b64 vcc, vcc, s[74:75]
    s_cbranch_vccz L_stok_2
    s_mov_b32 s65, 0x10000
    v_and_b32 v255, 0xf0, v252
L_st_1:
    buffer_load_dwordx3 v[248:250], v255, s[16:19], s45 offen sc1
    buffer_load_dwordx3 v[236:238], v255, s[16:19], s45 offen offset:256 sc1
    s_waitcnt vmcnt(0)
    v_cmp_ne_u32 vcc, s32, v250
    v_cmp_ne_u32 s[74:75], s32, v238
    s_nop 0
    s_or_b64 vcc, vcc, s[74:75]
    s_cbranch_vccz L_stok_2
    s_sub_u32 s65, s65, 1
    s_cbranch_scc0 L_st_1
    v_mov_b32 v240, 1
    v_mov_b32 v255, 0
    global_store_dword v255, v240, s[80:81]
L_stok_2:
    v_rcp_f32 v250, v249
    v_rcp_f32 v238, v237
    v_mul_f32 v250, s64, v250
    v_mul_f32 v238, s64, v238
    s_cmp_ge_u32 s34, 2
    s_cselect_b64 vcc, -1, 0
    ds_read_b64_tr_b16 v[192:193], v242 offset:49152
    ds_read_b64_tr_b16 v[194:195], v242 offset:51200
    ds_read_b64_tr_b16 v[200:201], v243 offset:49152
    ds_read_b64_tr_b16 v[202:203], v243 offset:51200
    s_add_u32 m0, s39, 114688
    s_add_u32 s47, s92, 54272
    buffer_load_dwordx4 v251, s[12:15], s92 offen lds
    v_mfma_f32_16x16x32_bf16 v[180:183], v[216:219], v[156:159], v[180:183]
    ds_read_b64_tr_b16 v[204:205], v242 offset:53248
    ds_read_b64_tr_b16 v[206:207], v242 offset:55296
    ds_read_b64_tr_b16 v[196:197], v243 offset:53248
    ds_read_b64_tr_b16 v[198:199], v243 offset:55296
    s_lshl_b32 s51, s35, 8
    v_mfma_f32_16x16x32_bf16 v[184:187], v[220:223], v[152:155], v[184:187]
    s_add_u32 s51, s51, 162304
    s_add_u32 s49, s52, s51
    v_add_u32 v255, s49, v253
    ds_read_b128 v[232:235], v255
    v_mfma_f32_16x16x32_bf16 v[188:191], v[220:223], v[156:159], v[188:191]
    s_waitcnt lgkmcnt(7)
    v_mfma_f32_16x16x32_bf16 v[208:211], v[192:195], v[0:3], 0
    buffer_load_dwordx4 v251, s[12:15], s47 offen offset:1024 lds
    v_mfma_f32_16x16x32_bf16 v[212:215], v[192:195], v[4:7], 0
    s_waitcnt lgkmcnt(0)
    v_fma_f32 v160, -v248, v232, v160
    v_fma_f32 v161, -v248, v233, v161
    v_fma_f32 v162, -v248, v234, v162
    s_cbranch_vccnz L_cs_4
    v_mfma_f32_16x16x32_bf16 v[224:227], v[192:195], v[228:231], 0
L_cs_4:
    v_fma_f32 v163, -v248, v235, v163
    v_fma_f32 v164, -v236, v232, v164
    v_fma_f32 v165, -v236, v233, v165
    v_fma_f32 v166, -v236, v234, v166
    v_mfma_f32_16x16x32_bf16 v[216:219], v[200:203], v[0:3], 0
    ds_read_b64_tr_b16 v[192:193], v242 offset:57344
    v_fma_f32 v167, -v236, v235, v167
    s_add_u32 s49, s53, s51
    v_add_u32 v255, s49, v253
    ds_read_b128 v[232:235], v255
    v_mfma_f32_16x16x32_bf16 v[220:223], v[200:203], v[4:7], 0
    ds_read_b64_tr_b16 v[194:195], v242 offset:59392
    v_mul_f32 v160, v160, v250
    v_mul_f32 v161, v161, v250
    v_mul_f32 v162, v162, v250
    v_mul_f32 v163, v163, v250
    v_mfma_f32_16x16x32_bf16 v[208:211], v[204:207], v[8:11], v[208:211]
    ds_read_b64_tr_b16 v[200:201], v243 offset:57344
    v_mul_f32 v164, v164, v238
    v_mul_f32 v165, v165, v238
    v_mul_f32 v166, v166, v238
    v_mul_f32 v167, v167, v238
    v_mfma_f32_16x16x32_bf16 v[212:215], v[204:207], v[12:15], v[212:215]
    ds_read_b64_tr_b16 v[202:203], v243 offset:59392
    s_lshl_b32 s50, s52, 6
    s_add_u32 s50, s50, s58
    v_cvt_pk_bf16_f32 v160, v160, v161
    v_cvt_pk_bf16_f32 v161, v162, v163
    s_cbranch_vccz L_cs_5
    v_mfma_f32_16x16x32_bf16 v[224:227], v[204:207], v[228:231], 0
L_cs_5:
    v_cvt_pk_bf16_f32 v162, v164, v165
    v_cvt_pk_bf16_f32 v163, v166, v167
    s_nop 0
    v_permlane16_swap_b32 v160, v162
    v_mfma_f32_16x16x32_bf16 v[216:219], v[196:199], v[8:11], v[216:219]
    ds_read_b64_tr_b16 v[204:205], v242 offset:61440
    v_permlane16_swap_b32 v161, v163
    buffer_store_dwordx4 v[160:163], v252, s[16:19], s50 offen sc1
    s_waitcnt lgkmcnt(4)
    v_mfma_f32_16x16x32_bf16 v[220:223], v[196:199], v[12:15], v[220:223]
    ds_read_b64_tr_b16 v[206:207], v242 offset:63488
    v_fma_f32 v168, -v248, v232, v168
    v_fma_f32 v169, -v248, v233, v169
    v_fma_f32 v170, -v248, v234, v170
    v_fma_f32 v171, -v248, v235, v171
    s_waitcnt lgkmcnt(4)
    v_mfma_f32_16x16x32_bf16 v[208:211], v[192:195], v[16:19], v[208:211]
    ds_read_b64_tr_b16 v[196:197], v243 offset:61440
    v_fma_f32 v172, -v236, v232, v172
    v_fma_f32 v173, -v236, v233, v173
    v_fma_f32 v174, -v236, v234, v174
    v_fma_f32 v175, -v236, v235, v175
    v_mfma_f32_16x16x32_bf16 v[212:215], v[192:195], v[20:23], v[212:215]
    ds_read_b64_tr_b16 v[198:199], v243 offset:63488
    s_add_u32 s49, s54, s51
    v_add_u32 v255, s49, v253
    ds_read_b128 v[232:235], v255
    v_mul_f32 v168, v168, v250
    s_cbranch_vccnz L_cs_6
    v_mfma_f32_16x16x32_bf16 v[224:227], v[192:195], v[228:231], v[224:227]
L_cs_6:
    v_mul_f32 v169, v169, v250
    v_mul_f32 v170, v170, v250
    v_mul_f32 v171, v171, v250
    v_mul_f32 v172, v172, v238
    s_waitcnt lgkmcnt(5)
    v_mfma_f32_16x16x32_bf16 v[216:219], v[200:203], v[16:19], v[216:219]
    s_waitcnt vmcnt(3)
    s_barrier
    ds_read_b64_tr_b16 v[192:193], v242 offset:16384
    s_add_u32 m0, s39, 49152
    s_add_u32 s47, s93, 54272
    buffer_load_dwordx4 v251, s[12:15], s93 offen lds
    v_mul_f32 v173, v173, v238
    v_mfma_f32_16x16x32_bf16 v[220:223], v[200:203], v[20:23], v[220:223]
    ds_read_b64_tr_b16 v[194:195], v242 offset:18432
    v_mul_f32 v174, v174, v238
    v_mul_f32 v175, v175, v238
    s_lshl_b32 s50, s53, 6
    s_add_u32 s50, s50, s58
    s_waitcnt lgkmcnt(5)
    v_mfma_f32_16x16x32_bf16 v[208:211], v[204:207], v[24:27], v[208:211]
    ds_read_b64_tr_b16 v[200:201], v243 offset:16384
    v_cvt_pk_bf16_f32 v168, v168, v169
    v_cvt_pk_bf16_f32 v169, v170, v171
    v_cvt_pk_bf16_f32 v170, v172, v173
    v_cvt_pk_bf16_f32 v171, v174, v175
    v_mfma_f32_16x16x32_bf16 v[212:215], v[204:207], v[28:31], v[212:215]
    ds_read_b64_tr_b16 v[202:203], v243 offset:18432
    v_permlane16_swap_b32 v168, v170
    v_permlane16_swap_b32 v169, v171
    s_cbranch_vccz L_cs_7
    v_mfma_f32_16x16x32_bf16 v[224:227], v[204:207], v[228:231], v[224:227]
L_cs_7:
    buffer_load_dwordx4 v251, s[12:15], s47 offen offset:1024 lds
    buffer_store_dwordx4 v[168:171], v252, s[16:19], s50 offen sc1
    s_waitcnt lgkmcnt(4)
    v_fma_f32 v176, -v248, v232, v176
    v_fma_f32 v177, -v248, v233, v177
    v_mfma_f32_16x16x32_bf16 v[216:219], v[196:199], v[24:27], v[216:219]
    ds_read_b64_tr_b16 v[204:205], v242 offset:20480
    v_fma_f32 v178, -v248, v234, v178
    v_fma_f32 v179, -v248, v235, v179
    v_fma_f32 v180, -v236, v232, v180
    v_fma_f32 v181, -v236, v233, v181
    v_mfma_f32_16x16x32_bf16 v[220:223], v[196:199], v[28:31], v[220:223]
    ds_read_b64_tr_b16 v[206:207], v242 offset:22528
    v_fma_f32 v182, -v236, v234, v182
    v_fma_f32 v183, -v236, v235, v183
    s_add_u32 s49, s55, s51
    v_add_u32 v255, s49, v253
    ds_read_b128 v[232:235], v255
    s_waitcnt lgkmcnt(5)
    v_mfma_f32_16x16x32_bf16 v[208:211], v[192:195], v[32:35], v[208:211]
    ds_read_b64_tr_b16 v[196:197], v243 offset:20480
    v_mul_f32 v176, v176, v250
    v_mul_f32 v177, v177, v250
    v_mul_f32 v178, v178, v250
    v_mfma_f32_16x16x32_bf16 v[212:215], v[192:195], v[36:39], v[212:215]
    ds_read_b64_tr_b16 v[198:199], v243 offset:22528
    s_add_u32 m0, s39, 0
    s_add_u32 s47, s96, 54272
    buffer_load_dwordx4 v251, s[12:15], s96 offen lds
    v_mul_f32 v179, v179, v250
    v_mul_f32 v180, v180, v238
    s_cbranch_vccnz L_cs_8
    v_mfma_f32_16x16x32_bf16 v[224:227], v[192:195], v[228:231], v[224:227]
L_cs_8:
    v_mul_f32 v181, v181, v238
    v_mul_f32 v182, v182, v238
    v_mul_f32 v183, v183, v238
    s_lshl_b32 s50, s54, 6
    s_waitcnt lgkmcnt(5)
    v_mfma_f32_16x16x32_bf16 v[216:219], v[200:203], v[32:35], v[216:219]
    ds_read_b64_tr_b16 v[192:193], v242 offset:24576
    s_add_u32 s50, s50, s58
    v_cvt_pk_bf16_f32 v176, v176, v177
    v_cvt_pk_bf16_f32 v177, v178, v179
    v_cvt_pk_bf16_f32 v178, v180, v181
    v_mfma_f32_16x16x32_bf16 v[220:223], v[200:203], v[36:39], v[220:223]
    ds_read_b64_tr_b16 v[194:195], v242 offset:26624
    v_cvt_pk_bf16_f32 v179, v182, v183
    v_permlane16_swap_b32 v176, v178
    s_nop 0
    v_permlane16_swap_b32 v177, v179
    s_waitcnt lgkmcnt(5)
    v_mfma_f32_16x16x32_bf16 v[208:211], v[204:207], v[40:43], v[208:211]
    ds_read_b64_tr_b16 v[200:201], v243 offset:24576
    buffer_load_dwordx4 v251, s[12:15], s47 offen offset:1024 lds
    buffer_store_dwordx4 v[176:179], v252, s[16:19], s50 offen sc1
    s_waitcnt lgkmcnt(5)
    v_fma_f32 v184, -v248, v232, v184
    v_mfma_f32_16x16x32_bf16 v[212:215], v[204:207], v[44:47], v[212:215]
    ds_read_b64_tr_b16 v[202:203], v243 offset:26624
    v_fma_f32 v185, -v248, v233, v185
    v_fma_f32 v186, -v248, v234, v186
    v_fma_f32 v187, -v248, v235, v187
    v_fma_f32 v188, -v236, v232, v188
    s_cbranch_vccz L_cs_9
    v_mfma_f32_16x16x32_bf16 v[224:227], v[204:207], v[228:231], v[224:227]
L_cs_9:
    v_fma_f32 v189, -v236, v233, v189
    v_fma_f32 v190, -v236, v234, v190
    v_fma_f32 v191, -v236, v235, v191
    v_mul_f32 v184, v184, v250
    s_waitcnt lgkmcnt(4)
    v_mfma_f32_16x16x32_bf16 v[216:219], v[196:199], v[40:43], v[216:219]
    ds_read_b64_tr_b16 v[204:205], v242 offset:28672
    v_mul_f32 v185, v185, v250
    v_mul_f32 v186, v186, v250
    v_mul_f32 v187, v187, v250
    v_mul_f32 v188, v188, v238
    v_mfma_f32_16x16x32_bf16 v[220:223], v[196:199], v[44:47], v[220:223]
    ds_read_b64_tr_b16 v[206:207], v242 offset:30720
    v_mul_f32 v189, v189, v238
    v_mul_f32 v190, v190, v238
    v_mul_f32 v191, v191, v238
    s_lshl_b32 s50, s55, 6
    s_waitcnt lgkmcnt(4)
    v_mfma_f32_16x16x32_bf16 v[208:211], v[192:195], v[48:51], v[208:211]
    ds_read_b64_tr_b16 v[196:197], v243 offset:28672
    s_add_u32 s50, s50, s58
    v_cvt_pk_bf16_f32 v184, v184, v185
    v_cvt_pk_bf16_f32 v185, v186, v187
    v_cvt_pk_bf16_f32 v186, v188, v189
    v_mfma_f32_16x16x32_bf16 v[212:215], v[192:195], v[52:55], v[212:215]
    ds_read_b64_tr_b16 v[198:199], v243 offset:30720
    v_cvt_pk_bf16_f32 v187, v190, v191
    v_permlane16_swap_b32 v184, v186
    s_nop 0
    v_permlane16_swap_b32 v185, v187
    s_cbranch_vccnz L_cs_10
    v_mfma_f32_16x16x32_bf16 v[224:227], v[192:195], v[228:231], v[224:227]
L_cs_10:
    buffer_store_dwordx4 v[184:187], v252, s[16:19], s50 offen sc1
    s_waitcnt lgkmcnt(4)
    v_mfma_f32_16x16x32_bf16 v[216:219], v[200:203], v[48:51], v[216:219]
    s_waitcnt vmcnt(8)
    s_barrier
    ds_read_b64_tr_b16 v[192:193], v242 offset:32768
    s_add_u32 m0, s39, 65536
    s_add_u32 s47, s94, 54272
    buffer_load_dwordx4 v251, s[12:15], s94 offen lds
    v_mfma_f32_16x16x32_bf16 v[220:223], v[200:203], v[52:55], v[220:223]
    ds_read_b64_tr_b16 v[194:195], v242 offset:34816
    s_waitcnt lgkmcnt(4)
    v_mfma_f32_16x16x32_bf16 v[208:211], v[204:207], v[56:59], v[208:211]
    ds_read_b64_tr_b16 v[200:201], v243 offset:32768
    v_mfma_f32_16x16x32_bf16 v[212:215], v[204:207], v[60:63], v[212:215]
    ds_read_b64_tr_b16 v[202:203], v243 offset:34816
    s_cbranch_vccz L_cs_11
    v_mfma_f32_16x16x32_bf16 v[224:227], v[204:207], v[228:231], v[224:227]
L_cs_11:
    buffer_load_dwordx4 v251, s[12:15], s47 offen offset:1024 lds
    s_waitcnt lgkmcnt(4)
    v_mfma_f32_16x16x32_bf16 v[216:219], v[196:199], v[56:59], v[216:219]
    ds_read_b64_tr_b16 v[204:205], v242 offset:36864
    v_mfma_f32_16x16x32_bf16 v[220:223], v[196:199], v[60:63], v[220:223]
    ds_read_b64_tr_b16 v[206:207], v242 offset:38912
    s_waitcnt lgkmcnt(4)
    v_mfma_f32_16x16x32_bf16 v[208:211], v[192:195], v[64:67], v[208:211]
    ds_read_b64_tr_b16 v[196:197], v243 offset:36864
    v_mfma_f32_16x16x32_bf16 v[212:215], v[192:195], v[68:71], v[212:215]
    ds_read_b64_tr_b16 v[198:199], v243 offset:38912
    s_add_u32 m0, s39, 16384
    s_add_u32 s47, s97, 54272
    buffer_load_dwordx4 v251, s[12:15], s97 offen lds
    s_cbranch_vccnz L_cs_12
    v_mfma_f32_16x16x32_bf16 v[224:227], v[192:195], v[228:231], v[224:227]
L_cs_12:
    s_waitcnt lgkmcnt(4)
    v_mfma_f32_16x16x32_bf16 v[216:219], v[200:203], v[64:67], v[216:219]
    ds_read_b64_tr_b16 v[192:193], v242 offset:40960
    v_mfma_f32_16x16x32_bf16 v[220:223], v[200:203], v[68:71], v[220:223]
    ds_read_b64_tr_b16 v[194:195], v242 offset:43008
    s_waitcnt lgkmcnt(4)
    v_mfma_f32_16x16x32_bf16 v[208:211], v[204:207], v[72:75], v[208:211]
    ds_read_b64_tr_b16 v[200:201], v243 offset:40960
    buffer_load_dwordx4 v251, s[12:15], s47 offen offset:1024 lds
    v_mfma_f32_16x16x32_bf16 v[212:215], v[204:207], v[76:79], v[212:215]
    ds_read_b64_tr_b16 v[202:203], v243 offset:43008
    s_cbranch_vccz L_cs_13
    v_mfma_f32_16x16x32_bf16 v[224:227], v[204:207], v[228:231], v[224:227]
L_cs_13:
    s_waitcnt lgkmcnt(4)
    v_mfma_f32_16x16x32_bf16 v[216:219], v[196:199], v[72:75], v[216:219]
    ds_read_b64_tr_b16 v[204:205], v242 offset:45056
    v_mfma_f32_16x16x32_bf16 v[220:223], v[196:199], v[76:79], v[220:223]
    ds_read_b64_tr_b16 v[206:207], v242 offset:47104
    s_waitcnt lgkmcnt(4)
    v_mfma_f32_16x16x32_bf16 v[208:211], v[192:195], v[80:83], v[208:211]
    ds_read_b64_tr_b16 v[196:197], v243 offset:45056
    v_mfma_f32_16x16x32_bf16 v[212:215], v[192:195], v[84:87], v[212:215]
    ds_read_b64_tr_b16 v[198:199], v243 offset:47104
    s_cbranch_vccnz L_cs_14
    v_mfma_f32_16x16x32_bf16 v[224:227], v[192:195], v[228:231], v[224:227]
L_cs_14:
    s_waitcnt lgkmcnt(4)
    v_mfma_f32_16x16x32_bf16 v[216:219], v[200:203], v[80:83], v[216:219]
    v_add_u32 v242, 0xffff8000, v242
    v_add_u32 v243, 0xffff8000, v243
    s_waitcnt vmcnt(9)
    s_barrier
    ds_read_b64_tr_b16 v[192:193], v242 offset:0
    s_add_u32 m0, s39, 81920
    s_add_u32 s47, s98, 54272
    buffer_load_dwordx4 v251, s[12:15], s98 offen lds
    v_mfma_f32_16x16x32_bf16 v[220:223], v[200:203], v[84:87], v[220:223]
    ds_read_b64_tr_b16 v[194:195], v242 offset:2048
    s_waitcnt lgkmcnt(4)
    v_mfma_f32_16x16x32_bf16 v[208:211], v[204:207], v[88:91], v[208:211]
    ds_read_b64_tr_b16 v[200:201], v243 offset:0
    v_mfma_f32_16x16x32_bf16 v[212:215], v[204:207], v[92:95], v[212:215]
    ds_read_b64_tr_b16 v[202:203], v243 offset:2048
    s_cbranch_vccz L_cs_15
    v_mfma_f32_16x16x32_bf16 v[224:227], v[204:207], v[228:231], v[224:227]
L_cs_15:
    buffer_load_dwordx4 v251, s[12:15], s47 offen offset:1024 lds
    s_waitcnt lgkmcnt(4)
    v_mfma_f32_16x16x32_bf16 v[216:219], v[196:199], v[88:91], v[216:219]
    ds_read_b64_tr_b16 v[204:205], v242 offset:4096
    v_mfma_f32_16x16x32_bf16 v[220:223], v[196:199], v[92:95], v[220:223]
    ds_read_b64_tr_b16 v[206:207], v242 offset:6144
    s_waitcnt lgkmcnt(4)
    v_mfma_f32_16x16x32_bf16 v[208:211], v[192:195], v[96:99], v[208:211]
    ds_read_b64_tr_b16 v[196:197], v243 offset:4096
    v_mfma_f32_16x16x32_bf16 v[212:215], v[192:195], v[100:103], v[212:215]
    ds_read_b64_tr_b16 v[198:199], v243 offset:6144
    s_add_u32 m0, s39, 131072
    s_add_u32 s47, s99, 54272
    buffer_load_dwordx4 v251, s[12:15], s99 offen lds
    s_cbranch_vccnz L_cs_16
    v_mfma_f32_16x16x32_bf16 v[224:227], v[192:195], v[228:231], v[224:227]
L_cs_16:
    s_waitcnt lgkmcnt(4)
    v_mfma_f32_16x16x32_bf16 v[216:219], v[200:203], v[96:99], v[216:219]
    ds_read_b64_tr_b16 v[192:193], v242 offset:8192
    v_mfma_f32_16x16x32_bf16 v[220:223], v[200:203], v[100:103], v[220:223]
    ds_read_b64_tr_b16 v[194:195], v242 offset:10240
    s_waitcnt vmcnt(7)
    v_mov_b32 v255, s32
    buffer_store_dword v255, v254, s[16:19], s61 offen sc1
    s_waitcnt lgkmcnt(4)
    v_mfma_f32_16x16x32_bf16 v[208:211], v[204:207], v[104:107], v[208:211]
    ds_read_b64_tr_b16 v[200:201], v243 offset:8192
    buffer_load_dwordx4 v251, s[12:15], s47 offen offset:1024 lds
    v_mfma_f32_16x16x32_bf16 v[212:215], v[204:207], v[108:111], v[212:215]
    ds_read_b64_tr_b16 v[202:203], v243 offset:10240
    s_cbranch_vccz L_cs_17
    v_mfma_f32_16x16x32_bf16 v[224:227], v[204:207], v[228:231], v[224:227]
L_cs_17:
    s_waitcnt lgkmcnt(4)
    v_mfma_f32_16x16x32_bf16 v[216:219], v[196:199], v[104:107], v[216:219]
    ds_read_b64_tr_b16 v[204:205], v242 offset:12288
    v_mfma_f32_16x16x32_bf16 v[220:223], v[196:199], v[108:111], v[220:223]
    ds_read_b64_tr_b16 v[206:207], v242 offset:14336
    s_waitcnt lgkmcnt(4)
    v_mfma_f32_16x16x32_bf16 v[208:211], v[192:195], v[112:115], v[208:211]
    ds_read_b64_tr_b16 v[196:197], v243 offset:12288
    v_mfma_f32_16x16x32_bf16 v[212:215], v[192:195], v[116:119], v[212:215]
    ds_read_b64_tr_b16 v[198:199], v243 offset:14336
    s_cbranch_vccnz L_cs_18
    v_mfma_f32_16x16x32_bf16 v[224:227], v[192:195], v[228:231], v[224:227]
L_cs_18:
    s_waitcnt lgkmcnt(4)
    v_mfma_f32_16x16x32_bf16 v[216:219], v[200:203], v[112:115], v[216:219]
    s_waitcnt vmcnt(7)
    s_barrier
    ds_read_b64_tr_b16 v[192:193], v242 offset:16384
    v_mfma_f32_16x16x32_bf16 v[220:223], v[200:203], v[116:119], v[220:223]
    ds_read_b64_tr_b16 v[194:195], v242 offset:18432
    s_cmp_ge_u32 s33, 4
    s_cselect_b64 exec, -1, 0
    buffer_load_dword v247, v241, s[16:19], 0 offen sc1
    v_mbcnt_lo_u32_b32 v246, -1, 0
    v_mbcnt_hi_u32_b32 v246, -1, v246
    v_lshlrev_b32 v246, 4, v246
    s_mov_b64 exec, -1
    s_waitcnt lgkmcnt(4)
    v_mfma_f32_16x16x32_bf16 v[208:211], v[204:207], v[120:123], v[208:211]
    ds_read_b64_tr_b16 v[200:201], v243 offset:16384
    v_mfma_f32_16x16x32_bf16 v[212:215], v[204:207], v[124:127], v[212:215]
    ds_read_b64_tr_b16 v[202:203], v243 offset:18432
    s_cbranch_vccz L_cs_19
    v_mfma_f32_16x16x32_bf16 v[224:227], v[204:207], v[228:231], v[224:227]
L_cs_19:
    s_waitcnt lgkmcnt(4)
    v_mfma_f32_16x16x32_bf16 v[216:219], v[196:199], v[120:123], v[216:219]
    ds_read_b64_tr_b16 v[204:205], v242 offset:20480
    v_mfma_f32_16x16x32_bf16 v[220:223], v[196:199], v[124:127], v[220:223]
    ds_read_b64_tr_b16 v[206:207], v242 offset:22528
    s_waitcnt lgkmcnt(4)
    v_mfma_f32_16x16x32_bf16 v[208:211], v[192:195], v[128:131], v[208:211]
    ds_read_b64_tr_b16 v[196:197], v243 offset:20480
    v_mfma_f32_16x16x32_bf16 v[212:215], v[192:195], v[132:135], v[212:215]
    ds_read_b64_tr_b16 v[198:199], v243 offset:22528
    s_cbranch_vccnz L_cs_20
    v_mfma_f32_16x16x32_bf16 v[224:227], v[192:195], v[228:231], v[224:227]
L_cs_20:
    s_waitcnt lgkmcnt(4)
    v_mfma_f32_16x16x32_bf16 v[216:219], v[200:203], v[128:131], v[216:219]
    ds_read_b64_tr_b16 v[192:193], v242 offset:24576
    v_mfma_f32_16x16x32_bf16 v[220:223], v[200:203], v[132:135], v[220:223]
    ds_read_b64_tr_b16 v[194:195], v242 offset:26624
    s_waitcnt lgkmcnt(4)
    v_mfma_f32_16x16x32_bf16 v[208:211], v[204:207], v[136:139], v[208:211]
    ds_read_b64_tr_b16 v[200:201], v243 offset:24576
    v_mfma_f32_16x16x32_bf16 v[212:215], v[204:207], v[140:143], v[212:215]
    ds_read_b64_tr_b16 v[202:203], v243 offset:26624
    s_cbranch_vccz L_cs_21
    v_mfma_f32_16x16x32_bf16 v[224:227], v[204:207], v[228:231], v[224:227]
L_cs_21:
    s_waitcnt lgkmcnt(4)
    v_mfma_f32_16x16x32_bf16 v[216:219], v[196:199], v[136:139], v[216:219]
    ds_read_b64_tr_b16 v[204:205], v242 offset:28672
    v_mfma_f32_16x16x32_bf16 v[220:223], v[196:199], v[140:143], v[220:223]
    ds_read_b64_tr_b16 v[206:207], v242 offset:30720
    s_waitcnt lgkmcnt(4)
    v_mfma_f32_16x16x32_bf16 v[208:211], v[192:195], v[144:147], v[208:211]
    ds_read_b64_tr_b16 v[196:197], v243 offset:28672
    v_mfma_f32_16x16x32_bf16 v[212:215], v[192:195], v[148:151], v[212:215]
    ds_read_b64_tr_b16 v[198:199], v243 offset:30720
    s_cbranch_vccnz L_cs_22
    v_mfma_f32_16x16x32_bf16 v[224:227], v[192:195], v[228:231], v[224:227]
L_cs_22:
    s_waitcnt lgkmcnt(4)
    v_mfma_f32_16x16x32_bf16 v[216:219], v[200:203], v[144:147], v[216:219]
    v_mfma_f32_16x16x32_bf16 v[220:223], v[200:203], v[148:151], v[220:223]
    s_waitcnt lgkmcnt(2)
    v_mfma_f32_16x16x32_bf16 v[208:211], v[204:207], v[152:155], v[208:211]
    v_mfma_f32_16x16x32_bf16 v[212:215], v[204:207], v[156:159], v[212:215]
    s_cbranch_vccz L_cs_23
    v_mfma_f32_16x16x32_bf16 v[224:227], v[204:207], v[228:231], v[224:227]
L_cs_23:
    s_add_u32 s51, s56, 162816
    v_add_u32 v255, s51, v253
    s_mov_b32 exec_lo, 0x00010001
    s_mov_b32 exec_hi, 0x00010001
    s_nop 3
    ds_add_f32 v255, v224 offset:0
    ds_add_f32 v255, v225 offset:4
    ds_add_f32 v255, v226 offset:8
    ds_add_f32 v255, v227 offset:12
    s_mov_b64 exec, -1
    s_waitcnt lgkmcnt(4)
    v_mfma_f32_16x16x32_bf16 v[216:219], v[196:199], v[152:155], v[216:219]
    v_mfma_f32_16x16x32_bf16 v[220:223], v[196:199], v[156:159], v[220:223]
    s_waitcnt vmcnt(1) lgkmcnt(0)
    s_barrier
    s_cmp_ge_u32 s33, 4
    s_cbranch_scc1 L_d
    s_add_u32 s49, s56, 162816
    v_add_u32 v255, s49, v253
    ds_read_b128 v[232:235], v255
    v_rcp_f32 v250, v249
    v_rcp_f32 v238, v237
    v_mul_f32 v250, 0xbfb8aa3b, v250
    v_mul_f32 v238, 0xbfb8aa3b, v238
    s_waitcnt lgkmcnt(0)
    v_fma_f32 v208, -v248, v232, v208
    v_fma_f32 v209, -v248, v233, v209
    v_fma_f32 v210, -v248, v234, v210
    v_fma_f32 v211, -v248, v235, v211
    v_fma_f32 v212, -v236, v232, v212
    v_fma_f32 v213, -v236, v233, v213
    v_fma_f32 v214, -v236, v234, v214
    v_fma_f32 v215, -v236, v235, v215
    s_add_u32 s49, s57, 162816
    v_add_u32 v255, s49, v253
    ds_read_b128 v[232:235], v255
    v_mul_f32 v239, v208, v250
    v_mul_f32 v251, v209, v250
    v_mul_f32 v245, v210, v250
    v_mul_f32 v247, v211, v250
    v_exp_f32 v239, v239
    v_exp_f32 v251, v251
    v_exp_f32 v245, v245
    v_exp_f32 v247, v247
    v_fma_f32 v239, v239, v249, v249
    v_fma_f32 v251, v251, v249, v249
    v_fma_f32 v245, v245, v249, v249
    v_fma_f32 v247, v247, v249, v249
    v_rcp_f32 v239, v239
    v_rcp_f32 v251, v251
    v_rcp_f32 v245, v245
    v_rcp_f32 v247, v247
    v_mul_f32 v208, v208, v239
    v_mul_f32 v209, v209, v251
    v_mul_f32 v210, v210, v245
    v_mul_f32 v211, v211, v247
    v_mul_f32 v239, v212, v238
    v_mul_f32 v251, v213, v238
    v_mul_f32 v245, v214, v238
    v_mul_f32 v247, v215, v238
    v_exp_f32 v239, v239
    v_exp_f32 v251, v251
    v_exp_f32 v245, v245
    v_exp_f32 v247, v247
    v_fma_f32 v239, v239, v237, v237
    v_fma_f32 v251, v251, v237, v237
    v_fma_f32 v245, v245, v237, v237
    v_fma_f32 v247, v247, v237, v237
    v_rcp_f32 v239, v239
    v_rcp_f32 v251, v251
    v_rcp_f32 v245, v245
    v_rcp_f32 v247, v247
    v_mul_f32 v212, v212, v239
    v_mul_f32 v213, v213, v251
    v_mul_f32 v214, v214, v245
    v_mul_f32 v215, v215, v247
    s_lshl_b32 s50, s56, 6
    s_add_u32 s50, s50, s59
    v_cvt_pk_bf16_f32 v208, v208, v209
    v_cvt_pk_bf16_f32 v209, v210, v211
    v_cvt_pk_bf16_f32 v210, v212, v213
    v_cvt_pk_bf16_f32 v211, v214, v215
    s_nop 0
    v_permlane16_swap_b32 v208, v210
    v_permlane16_swap_b32 v209, v211
    buffer_store_dwordx4 v[208:211], v252, s[16:19], s50 offen sc1
    s_waitcnt lgkmcnt(0)
    v_fma_f32 v216, -v248, v232, v216
    v_fma_f32 v217, -v248, v233, v217
    v_fma_f32 v218, -v248, v234, v218
    v_fma_f32 v219, -v248, v235, v219
    v_fma_f32 v220, -v236, v232, v220
    v_fma_f32 v221, -v236, v233, v221
    v_fma_f32 v222, -v236, v234, v222
    v_fma_f32 v223, -v236, v235, v223
    v_mul_f32 v239, v216, v250
    v_mul_f32 v251, v217, v250
    v_mul_f32 v245, v218, v250
    v_mul_f32 v247, v219, v250
    v_exp_f32 v239, v239
    v_exp_f32 v251, v251
    v_exp_f32 v245, v245
    v_exp_f32 v247, v247
    v_fma_f32 v239, v239, v249, v249
    v_fma_f32 v251, v251, v249, v249
    v_fma_f32 v245, v245, v249, v249
    v_fma_f32 v247, v247, v249, v249
    v_rcp_f32 v239, v239
    v_rcp_f32 v251, v251
    v_rcp_f32 v245, v245
    v_rcp_f32 v247, v247
    v_mul_f32 v216, v216, v239
    v_mul_f32 v217, v217, v251
    v_mul_f32 v218, v218, v245
    v_mul_f32 v219, v219, v247
    v_mul_f32 v239, v220, v238
    v_mul_f32 v251, v221, v238
    v_mul_f32 v245, v222, v238
    v_mul_f32 v247, v223, v238
    v_exp_f32 v239, v239
    v_exp_f32 v251, v251
    v_exp_f32 v245, v245
    v_exp_f32 v247, v247
    v_fma_f32 v239, v239, v237, v237
    v_fma_f32 v251, v251, v237, v237
    v_fma_f32 v245, v245, v237, v237
    v_fma_f32 v247, v247, v237, v237
    v_rcp_f32 v239, v239
    v_rcp_f32 v251, v251
    v_rcp_f32 v245, v245
    v_rcp_f32 v247, v247
    v_mul_f32 v220, v220, v239
    v_mul_f32 v221, v221, v251
    v_mul_f32 v222, v222, v245
    v_mul_f32 v223, v223, v247
    s_lshl_b32 s50, s57, 6
    s_add_u32 s50, s50, s59
    v_cvt_pk_bf16_f32 v216, v216, v217
    v_cvt_pk_bf16_f32 v217, v218, v219
    v_cvt_pk_bf16_f32 v218, v220, v221
    v_cvt_pk_bf16_f32 v219, v222, v223
    s_nop 0
    v_permlane16_swap_b32 v216, v218
    v_permlane16_swap_b32 v217, v219
    buffer_store_dwordx4 v[216:219], v252, s[16:19], s50 offen sc1
    s_cmp_ge_u32 s37, 11
    s_cbranch_scc1 L_three
    s_setprio 1
    s_lshr_b32 s70, s56, 1
    v_and_b32 v255, 0xfff, v242
    v_xor_b32 v255, s70, v255
    s_lshr_b32 s70, s52, 1
    v_xor_b32 v242, s70, v255
    s_lshr_b32 s70, s53, 1
    v_xor_b32 v243, s70, v255
    s_lshr_b32 s70, s54, 1
    v_xor_b32 v244, s70, v255
    s_lshr_b32 s70, s55, 1
    v_xor_b32 v245, s70, v255
    v_mov_b32 v232, 0x44444444
    s_mov_b32 exec_lo, 0xaaaaaaaa
    s_mov_b32 exec_hi, 0xaaaaaaaa
    v_mov_b32 v232, 0xeeeeeeee
    s_mov_b64 exec, -1
    v_mov_b32 v224, 0
    v_mov_b32 v225, 0
    v_mov_b32 v226, 0
    v_mov_b32 v227, 0
    ds_read_b64_tr_b16 v[200:201], v243 offset:32768
    ds_read_b64_tr_b16 v[202:203], v243 offset:34816
    ds_read_b64_tr_b16 v[204:205], v244 offset:32768
    ds_read_b64_tr_b16 v[206:207], v244 offset:34816
    ds_read_b64_tr_b16 v[208:209], v245 offset:32768
    ds_read_b64_tr_b16 v[210:211], v245 offset:34816
    ds_read_b64_tr_b16 v[192:193], v242 offset:32768
    ds_read_b64_tr_b16 v[194:195], v242 offset:34816
    ds_read_b64_tr_b16 v[196:197], v242 offset:36864
    ds_read_b64_tr_b16 v[198:199], v242 offset:38912
    ds_read_b64_tr_b16 v[212:213], v243 offset:36864
    ds_read_b64_tr_b16 v[214:215], v243 offset:38912
    s_waitcnt lgkmcnt(4)
    v_mfma_f32_16x16x32_bf16 v[160:163], v[192:195], v[0:3], 0
    ds_read_b64_tr_b16 v[216:217], v244 offset:36864
    v_mfma_f32_16x16x32_bf16 v[164:167], v[192:195], v[4:7], 0
    ds_read_b64_tr_b16 v[218:219], v244 offset:38912
    v_mfma_f32_16x16x32_bf16 v[168:171], v[200:203], v[0:3], 0
    ds_read_b64_tr_b16 v[220:221], v245 offset:36864
    v_mfma_f32_16x16x32_bf16 v[172:175], v[200:203], v[4:7], 0
    ds_read_b64_tr_b16 v[222:223], v245 offset:38912
    v_mfma_f32_16x16x32_bf16 v[176:179], v[204:207], v[0:3], 0
    ds_read_b64_tr_b16 v[200:201], v243 offset:40960
    v_mfma_f32_16x16x32_bf16 v[180:183], v[204:207], v[4:7], 0
    ds_read_b64_tr_b16 v[202:203], v243 offset:43008
    v_mfma_f32_16x16x32_bf16 v[184:187], v[208:211], v[0:3], 0
    ds_read_b64_tr_b16 v[204:205], v244 offset:40960
    v_mfma_f32_16x16x32_bf16 v[188:191], v[208:211], v[4:7], 0
    ds_read_b64_tr_b16 v[206:207], v244 offset:43008
    s_waitcnt lgkmcnt(10)
    v_mfma_f32_16x16x32_bf16 v[160:163], v[196:199], v[8:11], v[160:163]
    ds_read_b64_tr_b16 v[208:209], v245 offset:40960
    v_mfma_f32_16x16x32_bf16 v[164:167], v[196:199], v[12:15], v[164:167]
    ds_read_b64_tr_b16 v[210:211], v245 offset:43008
    v_smfmac_f32_16x16x64_bf16 v[224:227], v[228:231], v[192:199], v232
    s_waitcnt lgkmcnt(10)
    v_mfma_f32_16x16x32_bf16 v[168:171], v[212:215], v[8:11], v[168:171]
    ds_read_b64_tr_b16 v[192:193], v242 offset:40960
    v_mfma_f32_16x16x32_bf16 v[172:175], v[212:215], v[12:15], v[172:175]
    ds_read_b64_tr_b16 v[194:195], v242 offset:43008
    s_waitcnt lgkmcnt(10)
    v_mfma_f32_16x16x32_bf16 v[176:179], v[216:219], v[8:11], v[176:179]
    ds_read_b64_tr_b16 v[196:197], v242 offset:45056
    v_mfma_f32_16x16x32_bf16 v[180:183], v[216:219], v[12:15], v[180:183]
    ds_read_b64_tr_b16 v[198:199], v242 offset:47104
    s_waitcnt lgkmcnt(10)
    v_mfma_f32_16x16x32_bf16 v[184:187], v[220:223], v[8:11], v[184:187]
    ds_read_b64_tr_b16 v[212:213], v243 offset:45056
    v_mfma_f32_16x16x32_bf16 v[188:191], v[220:223], v[12:15], v[188:191]
    ds_read_b64_tr_b16 v[214:215], v243 offset:47104
    s_waitcnt lgkmcnt(4)
    v_mfma_f32_16x16x32_bf16 v[160:163], v[192:195], v[16:19], v[160:163]
    ds_read_b64_tr_b16 v[216:217], v244 offset:45056
    v_mfma_f32_16x16x32_bf16 v[164:167], v[192:195], v[20:23], v[164:167]
    ds_read_b64_tr_b16 v[218:219], v244 offset:47104
    v_mfma_f32_16x16x32_bf16 v[168:171], v[200:203], v[16:19], v[168:171]
    ds_read_b64_tr_b16 v[220:221], v245 offset:45056
    v_mfma_f32_16x16x32_bf16 v[172:175], v[200:203], v[20:23], v[172:175]
    ds_read_b64_tr_b16 v[222:223], v245 offset:47104
    v_mfma_f32_16x16x32_bf16 v[176:179], v[204:207], v[16:19], v[176:179]
    ds_read_b64_tr_b16 v[200:201], v243 offset:0
    v_mfma_f32_16x16x32_bf16 v[180:183], v[204:207], v[20:23], v[180:183]
    ds_read_b64_tr_b16 v[202:203], v243 offset:2048
    v_mfma_f32_16x16x32_bf16 v[184:187], v[208:211], v[16:19], v[184:187]
    ds_read_b64_tr_b16 v[204:205], v244 offset:0
    v_mfma_f32_16x16x32_bf16 v[188:191], v[208:211], v[20:23], v[188:191]
    ds_read_b64_tr_b16 v[206:207], v244 offset:2048
    s_waitcnt lgkmcnt(10)
    v_mfma_f32_16x16x32_bf16 v[160:163], v[196:199], v[24:27], v[160:163]
    ds_read_b64_tr_b16 v[208:209], v245 offset:0
    v_mfma_f32_16x16x32_bf16 v[164:167], v[196:199], v[28:31], v[164:167]
    ds_read_b64_tr_b16 v[210:211], v245 offset:2048
    v_smfmac_f32_16x16x64_bf16 v[224:227], v[228:231], v[192:199], v232
    s_waitcnt lgkmcnt(10)
    v_mfma_f32_16x16x32_bf16 v[168:171], v[212:215], v[24:27], v[168:171]
    ds_read_b64_tr_b16 v[192:193], v242 offset:0
    v_mfma_f32_16x16x32_bf16 v[172:175], v[212:215], v[28:31], v[172:175]
    ds_read_b64_tr_b16 v[194:195], v242 offset:2048
    s_waitcnt lgkmcnt(10)
    v_mfma_f32_16x16x32_bf16 v[176:179], v[216:219], v[24:27], v[176:179]
    ds_read_b64_tr_b16 v[196:197], v242 offset:4096
    v_mfma_f32_16x16x32_bf16 v[180:183], v[216:219], v[28:31], v[180:183]
    ds_read_b64_tr_b16 v[198:199], v242 offset:6144
    s_waitcnt lgkmcnt(10)
    v_mfma_f32_16x16x32_bf16 v[184:187], v[220:223], v[24:27], v[184:187]
    ds_read_b64_tr_b16 v[212:213], v243 offset:4096
    v_mfma_f32_16x16x32_bf16 v[188:191], v[220:223], v[28:31], v[188:191]
    ds_read_b64_tr_b16 v[214:215], v243 offset:6144
    s_waitcnt lgkmcnt(4)
    v_mfma_f32_16x16x32_bf16 v[160:163], v[192:195], v[32:35], v[160:163]
    ds_read_b64_tr_b16 v[216:217], v244 offset:4096
    v_mfma_f32_16x16x32_bf16 v[164:167], v[192:195], v[36:39], v[164:167]
    ds_read_b64_tr_b16 v[218:219], v244 offset:6144
    v_mfma_f32_16x16x32_bf16 v[168:171], v[200:203], v[32:35], v[168:171]
    ds_read_b64_tr_b16 v[220:221], v245 offset:4096
    v_mfma_f32_16x16x32_bf16 v[172:175], v[200:203], v[36:39], v[172:175]
    ds_read_b64_tr_b16 v[222:223], v245 offset:6144
    v_mfma_f32_16x16x32_bf16 v[176:179], v[204:207], v[32:35], v[176:179]
    ds_read_b64_tr_b16 v[200:201], v243 offset:8192
    v_mfma_f32_16x16x32_bf16 v[180:183], v[204:207], v[36:39], v[180:183]
    ds_read_b64_tr_b16 v[202:203], v243 offset:10240
    v_mfma_f32_16x16x32_bf16 v[184:187], v[208:211], v[32:35], v[184:187]
    ds_read_b64_tr_b16 v[204:205], v244 offset:8192
    v_mfma_f32_16x16x32_bf16 v[188:191], v[208:211], v[36:39], v[188:191]
    ds_read_b64_tr_b16 v[206:207], v244 offset:10240
    s_waitcnt vmcnt(0)
    v_mov_b32 v255, s32
    buffer_store_dword v255, v254, s[16:19], s62 offen sc1
    s_waitcnt lgkmcnt(10)
    v_mfma_f32_16x16x32_bf16 v[160:163], v[196:199], v[40:43], v[160:163]
    ds_read_b64_tr_b16 v[208:209], v245 offset:8192
    v_mfma_f32_16x16x32_bf16 v[164:167], v[196:199], v[44:47], v[164:167]
    ds_read_b64_tr_b16 v[210:211], v245 offset:10240
    v_smfmac_f32_16x16x64_bf16 v[224:227], v[228:231], v[192:199], v232
    s_waitcnt lgkmcnt(10)
    v_mfma_f32_16x16x32_bf16 v[168:171], v[212:215], v[40:43], v[168:171]
    ds_read_b64_tr_b16 v[192:193], v242 offset:8192
    v_mfma_f32_16x16x32_bf16 v[172:175], v[212:215], v[44:47], v[172:175]
    ds_read_b64_tr_b16 v[194:195], v242 offset:10240
    s_waitcnt lgkmcnt(10)
    v_mfma_f32_16x16x32_bf16 v[176:179], v[216:219], v[40:43], v[176:179]
    ds_read_b64_tr_b16 v[196:197], v242 offset:12288
    v_mfma_f32_16x16x32_bf16 v[180:183], v[216:219], v[44:47], v[180:183]
    ds_read_b64_tr_b16 v[198:199], v242 offset:14336
    s_waitcnt lgkmcnt(10)
    v_mfma_f32_16x16x32_bf16 v[184:187], v[220:223], v[40:43], v[184:187]
    ds_read_b64_tr_b16 v[212:213], v243 offset:12288
    v_mfma_f32_16x16x32_bf16 v[188:191], v[220:223], v[44:47], v[188:191]
    ds_read_b64_tr_b16 v[214:215], v243 offset:14336
    s_waitcnt lgkmcnt(4)
    v_mfma_f32_16x16x32_bf16 v[160:163], v[192:195], v[48:51], v[160:163]
    ds_read_b64_tr_b16 v[216:217], v244 offset:12288
    v_mfma_f32_16x16x32_bf16 v[164:167], v[192:195], v[52:55], v[164:167]
    ds_read_b64_tr_b16 v[218:219], v244 offset:14336
    v_mfma_f32_16x16x32_bf16 v[168:171], v[200:203], v[48:51], v[168:171]
    ds_read_b64_tr_b16 v[220:221], v245 offset:12288
    v_mfma_f32_16x16x32_bf16 v[172:175], v[200:203], v[52:55], v[172:175]
    ds_read_b64_tr_b16 v[222:223], v245 offset:14336
    v_mfma_f32_16x16x32_bf16 v[176:179], v[204:207], v[48:51], v[176:179]
    ds_read_b64_tr_b16 v[200:201], v243 offset:16384
    v_mfma_f32_16x16x32_bf16 v[180:183], v[204:207], v[52:55], v[180:183]
    ds_read_b64_tr_b16 v[202:203], v243 offset:18432
    v_mfma_f32_16x16x32_bf16 v[184:187], v[208:211], v[48:51], v[184:187]
    ds_read_b64_tr_b16 v[204:205], v244 offset:16384
    v_mfma_f32_16x16x32_bf16 v[188:191], v[208:211], v[52:55], v[188:191]
    ds_read_b64_tr_b16 v[206:207], v244 offset:18432
    s_waitcnt lgkmcnt(10)
    v_mfma_f32_16x16x32_bf16 v[160:163], v[196:199], v[56:59], v[160:163]
    ds_read_b64_tr_b16 v[208:209], v245 offset:16384
    v_mfma_f32_16x16x32_bf16 v[164:167], v[196:199], v[60:63], v[164:167]
    ds_read_b64_tr_b16 v[210:211], v245 offset:18432
    v_smfmac_f32_16x16x64_bf16 v[224:227], v[228:231], v[192:199], v232
    s_waitcnt lgkmcnt(10)
    v_mfma_f32_16x16x32_bf16 v[168:171], v[212:215], v[56:59], v[168:171]
    ds_read_b64_tr_b16 v[192:193], v242 offset:16384
    v_mfma_f32_16x16x32_bf16 v[172:175], v[212:215], v[60:63], v[172:175]
    ds_read_b64_tr_b16 v[194:195], v242 offset:18432
    s_waitcnt lgkmcnt(10)
    v_mfma_f32_16x16x32_bf16 v[176:179], v[216:219], v[56:59], v[176:179]
    ds_read_b64_tr_b16 v[196:197], v242 offset:20480
    v_mfma_f32_16x16x32_bf16 v[180:183], v[216:219], v[60:63], v[180:183]
    ds_read_b64_tr_b16 v[198:199], v242 offset:22528
    s_waitcnt lgkmcnt(10)
    v_mfma_f32_16x16x32_bf16 v[184:187], v[220:223], v[56:59], v[184:187]
    ds_read_b64_tr_b16 v[212:213], v243 offset:20480
    v_mfma_f32_16x16x32_bf16 v[188:191], v[220:223], v[60:63], v[188:191]
    ds_read_b64_tr_b16 v[214:215], v243 offset:22528
    s_waitcnt lgkmcnt(4)
    v_mfma_f32_16x16x32_bf16 v[160:163], v[192:195], v[64:67], v[160:163]
    ds_read_b64_tr_b16 v[216:217], v244 offset:20480
    v_mfma_f32_16x16x32_bf16 v[164:167], v[192:195], v[68:71], v[164:167]
    ds_read_b64_tr_b16 v[218:219], v244 offset:22528
    v_mfma_f32_16x16x32_bf16 v[168:171], v[200:203], v[64:67], v[168:171]
    ds_read_b64_tr_b16 v[220:221], v245 offset:20480
    v_mfma_f32_16x16x32_bf16 v[172:175], v[200:203], v[68:71], v[172:175]
    ds_read_b64_tr_b16 v[222:223], v245 offset:22528
    v_mfma_f32_16x16x32_bf16 v[176:179], v[204:207], v[64:67], v[176:179]
    ds_read_b64_tr_b16 v[200:201], v243 offset:24576
    v_mfma_f32_16x16x32_bf16 v[180:183], v[204:207], v[68:71], v[180:183]
    ds_read_b64_tr_b16 v[202:203], v243 offset:26624
    v_mfma_f32_16x16x32_bf16 v[184:187], v[208:211], v[64:67], v[184:187]
    ds_read_b64_tr_b16 v[204:205], v244 offset:24576
    v_mfma_f32_16x16x32_bf16 v[188:191], v[208:211], v[68:71], v[188:191]
    ds_read_b64_tr_b16 v[206:207], v244 offset:26624
    s_waitcnt lgkmcnt(10)
    v_mfma_f32_16x16x32_bf16 v[160:163], v[196:199], v[72:75], v[160:163]
    ds_read_b64_tr_b16 v[208:209], v245 offset:24576
    v_mfma_f32_16x16x32_bf16 v[164:167], v[196:199], v[76:79], v[164:167]
    ds_read_b64_tr_b16 v[210:211], v245 offset:26624
    v_smfmac_f32_16x16x64_bf16 v[224:227], v[228:231], v[192:199], v232
    s_waitcnt lgkmcnt(10)
    v_mfma_f32_16x16x32_bf16 v[168:171], v[212:215], v[72:75], v[168:171]
    ds_read_b64_tr_b16 v[192:193], v242 offset:24576
    v_mfma_f32_16x16x32_bf16 v[172:175], v[212:215], v[76:79], v[172:175]
    ds_read_b64_tr_b16 v[194:195], v242 offset:26624
    s_waitcnt lgkmcnt(10)
    v_mfma_f32_16x16x32_bf16 v[176:179], v[216:219], v[72:75], v[176:179]
    ds_read_b64_tr_b16 v[196:197], v242 offset:28672
    v_mfma_f32_16x16x32_bf16 v[180:183], v[216:219], v[76:79], v[180:183]
    ds_read_b64_tr_b16 v[198:199], v242 offset:30720
    s_waitcnt lgkmcnt(10)
    v_mfma_f32_16x16x32_bf16 v[184:187], v[220:223], v[72:75], v[184:187]
    ds_read_b64_tr_b16 v[212:213], v243 offset:28672
    v_mfma_f32_16x16x32_bf16 v[188:191], v[220:223], v[76:79], v[188:191]
    ds_read_b64_tr_b16 v[214:215], v243 offset:30720
    s_waitcnt lgkmcnt(4)
    v_mfma_f32_16x16x32_bf16 v[160:163], v[192:195], v[80:83], v[160:163]
    ds_read_b64_tr_b16 v[216:217], v244 offset:28672
    v_mfma_f32_16x16x32_bf16 v[164:167], v[192:195], v[84:87], v[164:167]
    ds_read_b64_tr_b16 v[218:219], v244 offset:30720
    v_mfma_f32_16x16x32_bf16 v[168:171], v[200:203], v[80:83], v[168:171]
    ds_read_b64_tr_b16 v[220:221], v245 offset:28672
    v_mfma_f32_16x16x32_bf16 v[172:175], v[200:203], v[84:87], v[172:175]
    ds_read_b64_tr_b16 v[222:223], v245 offset:30720
    v_mfma_f32_16x16x32_bf16 v[176:179], v[204:207], v[80:83], v[176:179]
    v_add_u32 v243, 81920, v243
    ds_read_b64_tr_b16 v[200:201], v243 offset:0
    v_mfma_f32_16x16x32_bf16 v[180:183], v[204:207], v[84:87], v[180:183]
    ds_read_b64_tr_b16 v[202:203], v243 offset:2048
    v_mfma_f32_16x16x32_bf16 v[184:187], v[208:211], v[80:83], v[184:187]
    v_add_u32 v244, 81920, v244
    ds_read_b64_tr_b16 v[204:205], v244 offset:0
    v_mfma_f32_16x16x32_bf16 v[188:191], v[208:211], v[84:87], v[188:191]
    ds_read_b64_tr_b16 v[206:207], v244 offset:2048
    s_waitcnt lgkmcnt(10)
    v_mfma_f32_16x16x32_bf16 v[160:163], v[196:199], v[88:91], v[160:163]
    v_add_u32 v245, 81920, v245
    v_mfma_f32_16x16x32_bf16 v[164:167], v[196:199], v[92:95], v[164:167]
    ds_read_b64_tr_b16 v[208:209], v245 offset:0
    v_smfmac_f32_16x16x64_bf16 v[224:227], v[228:231], v[192:199], v232
    ds_read_b64_tr_b16 v[210:211], v245 offset:2048
    s_waitcnt lgkmcnt(10)
    v_mfma_f32_16x16x32_bf16 v[168:171], v[212:215], v[88:91], v[168:171]
    v_add_u32 v242, 81920, v242
    ds_read_b64_tr_b16 v[192:193], v242 offset:0
    v_mfma_f32_16x16x32_bf16 v[172:175], v[212:215], v[92:95], v[172:175]
    ds_read_b64_tr_b16 v[194:195], v242 offset:2048
    s_waitcnt lgkmcnt(10)
    v_mfma_f32_16x16x32_bf16 v[176:179], v[216:219], v[88:91], v[176:179]
    ds_read_b64_tr_b16 v[196:197], v242 offset:4096
    v_mfma_f32_16x16x32_bf16 v[180:183], v[216:219], v[92:95], v[180:183]
    ds_read_b64_tr_b16 v[198:199], v242 offset:6144
    s_waitcnt lgkmcnt(10)
    v_mfma_f32_16x16x32_bf16 v[184:187], v[220:223], v[88:91], v[184:187]
    ds_read_b64_tr_b16 v[212:213], v243 offset:4096
    v_mfma_f32_16x16x32_bf16 v[188:191], v[220:223], v[92:95], v[188:191]
    ds_read_b64_tr_b16 v[214:215], v243 offset:6144
    s_waitcnt lgkmcnt(4)
    v_mfma_f32_16x16x32_bf16 v[160:163], v[192:195], v[96:99], v[160:163]
    ds_read_b64_tr_b16 v[216:217], v244 offset:4096
    v_mfma_f32_16x16x32_bf16 v[164:167], v[192:195], v[100:103], v[164:167]
    ds_read_b64_tr_b16 v[218:219], v244 offset:6144
    v_mfma_f32_16x16x32_bf16 v[168:171], v[200:203], v[96:99], v[168:171]
    ds_read_b64_tr_b16 v[220:221], v245 offset:4096
    v_mfma_f32_16x16x32_bf16 v[172:175], v[200:203], v[100:103], v[172:175]
    ds_read_b64_tr_b16 v[222:223], v245 offset:6144
    v_mfma_f32_16x16x32_bf16 v[176:179], v[204:207], v[96:99], v[176:179]
    ds_read_b64_tr_b16 v[200:201], v243 offset:8192
    v_mfma_f32_16x16x32_bf16 v[180:183], v[204:207], v[100:103], v[180:183]
    ds_read_b64_tr_b16 v[202:203], v243 offset:10240
    v_mfma_f32_16x16x32_bf16 v[184:187], v[208:211], v[96:99], v[184:187]
    ds_read_b64_tr_b16 v[204:205], v244 offset:8192
    v_mfma_f32_16x16x32_bf16 v[188:191], v[208:211], v[100:103], v[188:191]
    ds_read_b64_tr_b16 v[206:207], v244 offset:10240
    s_waitcnt lgkmcnt(10)
    v_mfma_f32_16x16x32_bf16 v[160:163], v[196:199], v[104:107], v[160:163]
    ds_read_b64_tr_b16 v[208:209], v245 offset:8192
    v_mfma_f32_16x16x32_bf16 v[164:167], v[196:199], v[108:111], v[164:167]
    ds_read_b64_tr_b16 v[210:211], v245 offset:10240
    v_smfmac_f32_16x16x64_bf16 v[224:227], v[228:231], v[192:199], v232
    s_waitcnt lgkmcnt(10)
    v_mfma_f32_16x16x32_bf16 v[168:171], v[212:215], v[104:107], v[168:171]
    ds_read_b64_tr_b16 v[192:193], v242 offset:8192
    v_mfma_f32_16x16x32_bf16 v[172:175], v[212:215], v[108:111], v[172:175]
    ds_read_b64_tr_b16 v[194:195], v242 offset:10240
    s_waitcnt lgkmcnt(10)
    v_mfma_f32_16x16x32_bf16 v[176:179], v[216:219], v[104:107], v[176:179]
    ds_read_b64_tr_b16 v[196:197], v242 offset:12288
    v_mfma_f32_16x16x32_bf16 v[180:183], v[216:219], v[108:111], v[180:183]
    ds_read_b64_tr_b16 v[198:199], v242 offset:14336
    s_waitcnt lgkmcnt(10)
    v_mfma_f32_16x16x32_bf16 v[184:187], v[220:223], v[104:107], v[184:187]
    ds_read_b64_tr_b16 v[212:213], v243 offset:12288
    v_mfma_f32_16x16x32_bf16 v[188:191], v[220:223], v[108:111], v[188:191]
    ds_read_b64_tr_b16 v[214:215], v243 offset:14336
    s_waitcnt lgkmcnt(4)
    v_mfma_f32_16x16x32_bf16 v[160:163], v[192:195], v[112:115], v[160:163]
    ds_read_b64_tr_b16 v[216:217], v244 offset:12288
    v_mfma_f32_16x16x32_bf16 v[164:167], v[192:195], v[116:119], v[164:167]
    ds_read_b64_tr_b16 v[218:219], v244 offset:14336
    v_mfma_f32_16x16x32_bf16 v[168:171], v[200:203], v[112:115], v[168:171]
    ds_read_b64_tr_b16 v[220:221], v245 offset:12288
    v_mfma_f32_16x16x32_bf16 v[172:175], v[200:203], v[116:119], v[172:175]
    ds_read_b64_tr_b16 v[222:223], v245 offset:14336
    v_mfma_f32_16x16x32_bf16 v[176:179], v[204:207], v[112:115], v[176:179]
    ds_read_b64_tr_b16 v[200:201], v243 offset:49152
    v_mfma_f32_16x16x32_bf16 v[180:183], v[204:207], v[116:119], v[180:183]
    ds_read_b64_tr_b16 v[202:203], v243 offset:51200
    v_mfma_f32_16x16x32_bf16 v[184:187], v[208:211], v[112:115], v[184:187]
    ds_read_b64_tr_b16 v[204:205], v244 offset:49152
    v_mfma_f32_16x16x32_bf16 v[188:191], v[208:211], v[116:119], v[188:191]
    ds_read_b64_tr_b16 v[206:207], v244 offset:51200
    s_waitcnt lgkmcnt(10)
    v_mfma_f32_16x16x32_bf16 v[160:163], v[196:199], v[120:123], v[160:163]
    ds_read_b64_tr_b16 v[208:209], v245 offset:49152
    v_mfma_f32_16x16x32_bf16 v[164:167], v[196:199], v[124:127], v[164:167]
    ds_read_b64_tr_b16 v[210:211], v245 offset:51200
    v_smfmac_f32_16x16x64_bf16 v[224:227], v[228:231], v[192:199], v232
    s_waitcnt lgkmcnt(10)
    v_mfma_f32_16x16x32_bf16 v[168:171], v[212:215], v[120:123], v[168:171]
    ds_read_b64_tr_b16 v[192:193], v242 offset:49152
    v_mfma_f32_16x16x32_bf16 v[172:175], v[212:215], v[124:127], v[172:175]
    ds_read_b64_tr_b16 v[194:195], v242 offset:51200
    s_waitcnt lgkmcnt(10)
    v_mfma_f32_16x16x32_bf16 v[176:179], v[216:219], v[120:123], v[176:179]
    ds_read_b64_tr_b16 v[196:197], v242 offset:53248
    v_mfma_f32_16x16x32_bf16 v[180:183], v[216:219], v[124:127], v[180:183]
    ds_read_b64_tr_b16 v[198:199], v242 offset:55296
    s_waitcnt lgkmcnt(10)
    v_mfma_f32_16x16x32_bf16 v[184:187], v[220:223], v[120:123], v[184:187]
    ds_read_b64_tr_b16 v[212:213], v243 offset:53248
    v_mfma_f32_16x16x32_bf16 v[188:191], v[220:223], v[124:127], v[188:191]
    ds_read_b64_tr_b16 v[214:215], v243 offset:55296
    s_waitcnt lgkmcnt(4)
    v_mfma_f32_16x16x32_bf16 v[160:163], v[192:195], v[128:131], v[160:163]
    ds_read_b64_tr_b16 v[216:217], v244 offset:53248
    v_mfma_f32_16x16x32_bf16 v[164:167], v[192:195], v[132:135], v[164:167]
    ds_read_b64_tr_b16 v[218:219], v244 offset:55296
    v_mfma_f32_16x16x32_bf16 v[168:171], v[200:203], v[128:131], v[168:171]
    ds_read_b64_tr_b16 v[220:221], v245 offset:53248
    v_mfma_f32_16x16x32_bf16 v[172:175], v[200:203], v[132:135], v[172:175]
    ds_read_b64_tr_b16 v[222:223], v245 offset:55296
    v_mfma_f32_16x16x32_bf16 v[176:179], v[204:207], v[128:131], v[176:179]
    ds_read_b64_tr_b16 v[200:201], v243 offset:57344
    v_mfma_f32_16x16x32_bf16 v[180:183], v[204:207], v[132:135], v[180:183]
    ds_read_b64_tr_b16 v[202:203], v243 offset:59392
    v_mfma_f32_16x16x32_bf16 v[184:187], v[208:211], v[128:131], v[184:187]
    ds_read_b64_tr_b16 v[204:205], v244 offset:57344
    v_mfma_f32_16x16x32_bf16 v[188:191], v[208:211], v[132:135], v[188:191]
    ds_read_b64_tr_b16 v[206:207], v244 offset:59392
    s_waitcnt lgkmcnt(10)
    v_mfma_f32_16x16x32_bf16 v[160:163], v[196:199], v[136:139], v[160:163]
    ds_read_b64_tr_b16 v[208:209], v245 offset:57344
    v_mfma_f32_16x16x32_bf16 v[164:167], v[196:199], v[140:143], v[164:167]
    ds_read_b64_tr_b16 v[210:211], v245 offset:59392
    v_smfmac_f32_16x16x64_bf16 v[224:227], v[228:231], v[192:199], v232
    s_waitcnt lgkmcnt(10)
    v_mfma_f32_16x16x32_bf16 v[168:171], v[212:215], v[136:139], v[168:171]
    ds_read_b64_tr_b16 v[192:193], v242 offset:57344
    v_mfma_f32_16x16x32_bf16 v[172:175], v[212:215], v[140:143], v[172:175]
    ds_read_b64_tr_b16 v[194:195], v242 offset:59392
    s_waitcnt lgkmcnt(10)
    v_mfma_f32_16x16x32_bf16 v[176:179], v[216:219], v[136:139], v[176:179]
    ds_read_b64_tr_b16 v[196:197], v242 offset:61440
    v_mfma_f32_16x16x32_bf16 v[180:183], v[216:219], v[140:143], v[180:183]
    ds_read_b64_tr_b16 v[198:199], v242 offset:63488
    s_waitcnt lgkmcnt(10)
    v_mfma_f32_16x16x32_bf16 v[184:187], v[220:223], v[136:139], v[184:187]
    ds_read_b64_tr_b16 v[212:213], v243 offset:61440
    v_mfma_f32_16x16x32_bf16 v[188:191], v[220:223], v[140:143], v[188:191]
    ds_read_b64_tr_b16 v[214:215], v243 offset:63488
    s_waitcnt lgkmcnt(4)
    v_mfma_f32_16x16x32_bf16 v[160:163], v[192:195], v[144:147], v[160:163]
    ds_read_b64_tr_b16 v[216:217], v244 offset:61440
    v_mfma_f32_16x16x32_bf16 v[164:167], v[192:195], v[148:151], v[164:167]
    ds_read_b64_tr_b16 v[218:219], v244 offset:63488
    v_mfma_f32_16x16x32_bf16 v[168:171], v[200:203], v[144:147], v[168:171]
    ds_read_b64_tr_b16 v[220:221], v245 offset:61440
    v_mfma_f32_16x16x32_bf16 v[172:175], v[200:203], v[148:151], v[172:175]
    ds_read_b64_tr_b16 v[222:223], v245 offset:63488
    v_mfma_f32_16x16x32_bf16 v[176:179], v[204:207], v[144:147], v[176:179]
    v_mfma_f32_16x16x32_bf16 v[180:183], v[204:207], v[148:151], v[180:183]
    v_mfma_f32_16x16x32_bf16 v[184:187], v[208:211], v[144:147], v[184:187]
    v_mfma_f32_16x16x32_bf16 v[188:191], v[208:211], v[148:151], v[188:191]
    s_waitcnt lgkmcnt(6)
    v_mfma_f32_16x16x32_bf16 v[160:163], v[196:199], v[152:155], v[160:163]
    v_mfma_f32_16x16x32_bf16 v[164:167], v[196:199], v[156:159], v[164:167]
    v_smfmac_f32_16x16x64_bf16 v[224:227], v[228:231], v[192:199], v232
    s_waitcnt lgkmcnt(4)
    v_mfma_f32_16x16x32_bf16 v[168:171], v[212:215], v[152:155], v[168:171]
    v_mfma_f32_16x16x32_bf16 v[172:175], v[212:215], v[156:159], v[172:175]
    s_waitcnt lgkmcnt(2)
    v_mfma_f32_16x16x32_bf16 v[176:179], v[216:219], v[152:155], v[176:179]
    v_mfma_f32_16x16x32_bf16 v[180:183], v[216:219], v[156:159], v[180:183]
    v_bfe_u32 v255, v252, 4, 4
    s_add_u32 s51, s52, 163072
    v_lshl_add_u32 v255, v255, 2, s51
    v_add_f32 v224, v224, v225
    s_mov_b64 exec, 0xffff
    ds_write_b32 v255, v224
    s_mov_b64 exec, -1
    v_mov_b32 v255, 163328
    v_mov_b32 v235, 1
    s_mov_b64 exec, 1
    ds_add_u32 v255, v235
    s_mov_b64 exec, -1
    s_waitcnt lgkmcnt(2)
    v_mfma_f32_16x16x32_bf16 v[184:187], v[220:223], v[152:155], v[184:187]
    v_mfma_f32_16x16x32_bf16 v[188:191], v[220:223], v[156:159], v[188:191]
    s_add_u32 s62, s62, 2048
    s_add_u32 s59, s59, 262144
    s_mov_b32 s65, 0x80000
L_lw_24:
    ds_read_b32 v235, v255
    s_waitcnt lgkmcnt(0)
    v_cmp_gt_u32 vcc, 8, v235
    s_cbranch_vccz L_lwd_25
    s_sub_u32 s65, s65, 1
    s_cbranch_scc0 L_lw_24
    v_mov_b32 v235, 9
    v_mov_b32 v255, 0
    global_store_dword v255, v235, s[80:81]
L_lwd_25:
    s_add_u32 s49, s52, 163072
    v_add_u32 v255, s49, v253
    ds_read_b128 v[0:3], v255
    s_waitcnt lgkmcnt(0)
    v_fma_f32 v160, -v248, v0, v160
    v_fma_f32 v161, -v248, v1, v161
    v_fma_f32 v162, -v248, v2, v162
    v_fma_f32 v163, -v248, v3, v163
    v_fma_f32 v164, -v236, v0, v164
    v_fma_f32 v165, -v236, v1, v165
    v_fma_f32 v166, -v236, v2, v166
    v_fma_f32 v167, -v236, v3, v167
    s_add_u32 s49, s53, 163072
    v_add_u32 v255, s49, v253
    ds_read_b128 v[0:3], v255
    v_mul_f32 v4, v160, v250
    v_mul_f32 v5, v161, v250
    v_mul_f32 v6, v162, v250
    v_mul_f32 v7, v163, v250
    v_exp_f32 v4, v4
    v_exp_f32 v5, v5
    v_exp_f32 v6, v6
    v_exp_f32 v7, v7
    v_fma_f32 v4, v4, v249, v249
    v_fma_f32 v5, v5, v249, v249
    v_fma_f32 v6, v6, v249, v249
    v_fma_f32 v7, v7, v249, v249
    v_rcp_f32 v4, v4
    v_rcp_f32 v5, v5
    v_rcp_f32 v6, v6
    v_rcp_f32 v7, v7
    v_mul_f32 v160, v160, v4
    v_mul_f32 v161, v161, v5
    v_mul_f32 v162, v162, v6
    v_mul_f32 v163, v163, v7
    v_mul_f32 v4, v164, v238
    v_mul_f32 v5, v165, v238
    v_mul_f32 v6, v166, v238
    v_mul_f32 v7, v167, v238
    v_exp_f32 v4, v4
    v_exp_f32 v5, v5
    v_exp_f32 v6, v6
    v_exp_f32 v7, v7
    v_fma_f32 v4, v4, v237, v237
    v_fma_f32 v5, v5, v237, v237
    v_fma_f32 v6, v6, v237, v237
    v_fma_f32 v7, v7, v237, v237
    v_rcp_f32 v4, v4
    v_rcp_f32 v5, v5
    v_rcp_f32 v6, v6
    v_rcp_f32 v7, v7
    v_mul_f32 v164, v164, v4
    v_mul_f32 v165, v165, v5
    v_mul_f32 v166, v166, v6
    v_mul_f32 v167, v167, v7
    s_lshl_b32 s50, s52, 6
    s_add_u32 s50, s50, s59
    v_cvt_pk_bf16_f32 v160, v160, v161
    v_cvt_pk_bf16_f32 v161, v162, v163
    v_cvt_pk_bf16_f32 v162, v164, v165
    v_cvt_pk_bf16_f32 v163, v166, v167
    s_nop 0
    v_permlane16_swap_b32 v160, v162
    v_permlane16_swap_b32 v161, v163
    buffer_store_dwordx4 v[160:163], v252, s[16:19], s50 offen sc1
    s_waitcnt lgkmcnt(0)
    v_fma_f32 v168, -v248, v0, v168
    v_fma_f32 v169, -v248, v1, v169
    v_fma_f32 v170, -v248, v2, v170
    v_fma_f32 v171, -v248, v3, v171
    v_fma_f32 v172, -v236, v0, v172
    v_fma_f32 v173, -v236, v1, v173
    v_fma_f32 v174, -v236, v2, v174
    v_fma_f32 v175, -v236, v3, v175
    s_add_u32 s49, s54, 163072
    v_add_u32 v255, s49, v253
    ds_read_b128 v[0:3], v255
    v_mul_f32 v4, v168, v250
    v_mul_f32 v5, v169, v250
    v_mul_f32 v6, v170, v250
    v_mul_f32 v7, v171, v250
    v_exp_f32 v4, v4
    v_exp_f32 v5, v5
    v_exp_f32 v6, v6
    v_exp_f32 v7, v7
    v_fma_f32 v4, v4, v249, v249
    v_fma_f32 v5, v5, v249, v249
    v_fma_f32 v6, v6, v249, v249
    v_fma_f32 v7, v7, v249, v249
    v_rcp_f32 v4, v4
    v_rcp_f32 v5, v5
    v_rcp_f32 v6, v6
    v_rcp_f32 v7, v7
    v_mul_f32 v168, v168, v4
    v_mul_f32 v169, v169, v5
    v_mul_f32 v170, v170, v6
    v_mul_f32 v171, v171, v7
    v_mul_f32 v4, v172, v238
    v_mul_f32 v5, v173, v238
    v_mul_f32 v6, v174, v238
    v_mul_f32 v7, v175, v238
    v_exp_f32 v4, v4
    v_exp_f32 v5, v5
    v_exp_f32 v6, v6
    v_exp_f32 v7, v7
    v_fma_f32 v4, v4, v237, v237
    v_fma_f32 v5, v5, v237, v237
    v_fma_f32 v6, v6, v237, v237
    v_fma_f32 v7, v7, v237, v237
    v_rcp_f32 v4, v4
    v_rcp_f32 v5, v5
    v_rcp_f32 v6, v6
    v_rcp_f32 v7, v7
    v_mul_f32 v172, v172, v4
    v_mul_f32 v173, v173, v5
    v_mul_f32 v174, v174, v6
    v_mul_f32 v175, v175, v7
    s_lshl_b32 s50, s53, 6
    s_add_u32 s50, s50, s59
    v_cvt_pk_bf16_f32 v168, v168, v169
    v_cvt_pk_bf16_f32 v169, v170, v171
    v_cvt_pk_bf16_f32 v170, v172, v173
    v_cvt_pk_bf16_f32 v171, v174, v175
    s_nop 0
    v_permlane16_swap_b32 v168, v170
    v_permlane16_swap_b32 v169, v171
    buffer_store_dwordx4 v[168:171], v252, s[16:19], s50 offen sc1
    s_waitcnt lgkmcnt(0)
    v_fma_f32 v176, -v248, v0, v176
    v_fma_f32 v177, -v248, v1, v177
    v_fma_f32 v178, -v248, v2, v178
    v_fma_f32 v179, -v248, v3, v179
    v_fma_f32 v180, -v236, v0, v180
    v_fma_f32 v181, -v236, v1, v181
    v_fma_f32 v182, -v236, v2, v182
    v_fma_f32 v183, -v236, v3, v183
    s_add_u32 s49, s55, 163072
    v_add_u32 v255, s49, v253
    ds_read_b128 v[0:3], v255
    v_mul_f32 v4, v176, v250
    v_mul_f32 v5, v177, v250
    v_mul_f32 v6, v178, v250
    v_mul_f32 v7, v179, v250
    v_exp_f32 v4, v4
    v_exp_f32 v5, v5
    v_exp_f32 v6, v6
    v_exp_f32 v7, v7
    v_fma_f32 v4, v4, v249, v249
    v_fma_f32 v5, v5, v249, v249
    v_fma_f32 v6, v6, v249, v249
    v_fma_f32 v7, v7, v249, v249
    v_rcp_f32 v4, v4
    v_rcp_f32 v5, v5
    v_rcp_f32 v6, v6
    v_rcp_f32 v7, v7
    v_mul_f32 v176, v176, v4
    v_mul_f32 v177, v177, v5
    v_mul_f32 v178, v178, v6
    v_mul_f32 v179, v179, v7
    v_mul_f32 v4, v180, v238
    v_mul_f32 v5, v181, v238
    v_mul_f32 v6, v182, v238
    v_mul_f32 v7, v183, v238
    v_exp_f32 v4, v4
    v_exp_f32 v5, v5
    v_exp_f32 v6, v6
    v_exp_f32 v7, v7
    v_fma_f32 v4, v4, v237, v237
    v_fma_f32 v5, v5, v237, v237
    v_fma_f32 v6, v6, v237, v237
    v_fma_f32 v7, v7, v237, v237
    v_rcp_f32 v4, v4
    v_rcp_f32 v5, v5
    v_rcp_f32 v6, v6
    v_rcp_f32 v7, v7
    v_mul_f32 v180, v180, v4
    v_mul_f32 v181, v181, v5
    v_mul_f32 v182, v182, v6
    v_mul_f32 v183, v183, v7
    s_lshl_b32 s50, s54, 6
    s_add_u32 s50, s50, s59
    v_cvt_pk_bf16_f32 v176, v176, v177
    v_cvt_pk_bf16_f32 v177, v178, v179
    v_cvt_pk_bf16_f32 v178, v180, v181
    v_cvt_pk_bf16_f32 v179, v182, v183
    s_nop 0
    v_permlane16_swap_b32 v176, v178
    v_permlane16_swap_b32 v177, v179
    buffer_store_dwordx4 v[176:179], v252, s[16:19], s50 offen sc1
    s_waitcnt lgkmcnt(0)
    v_fma_f32 v184, -v248, v0, v184
    v_fma_f32 v185, -v248, v1, v185
    v_fma_f32 v186, -v248, v2, v186
    v_fma_f32 v187, -v248, v3, v187
    v_fma_f32 v188, -v236, v0, v188
    v_fma_f32 v189, -v236, v1, v189
    v_fma_f32 v190, -v236, v2, v190
    v_fma_f32 v191, -v236, v3, v191
    v_mul_f32 v4, v184, v250
    v_mul_f32 v5, v185, v250
    v_mul_f32 v6, v186, v250
    v_mul_f32 v7, v187, v250
    v_exp_f32 v4, v4
    v_exp_f32 v5, v5
    v_exp_f32 v6, v6
    v_exp_f32 v7, v7
    v_fma_f32 v4, v4, v249, v249
    v_fma_f32 v5, v5, v249, v249
    v_fma_f32 v6, v6, v249, v249
    v_fma_f32 v7, v7, v249, v249
    v_rcp_f32 v4, v4
    v_rcp_f32 v5, v5
    v_rcp_f32 v6, v6
    v_rcp_f32 v7, v7
    v_mul_f32 v184, v184, v4
    v_mul_f32 v185, v185, v5
    v_mul_f32 v186, v186, v6
    v_mul_f32 v187, v187, v7
    v_mul_f32 v4, v188, v238
    v_mul_f32 v5, v189, v238
    v_mul_f32 v6, v190, v238
    v_mul_f32 v7, v191, v238
    v_exp_f32 v4, v4
    v_exp_f32 v5, v5
    v_exp_f32 v6, v6
    v_exp_f32 v7, v7
    v_fma_f32 v4, v4, v237, v237
    v_fma_f32 v5, v5, v237, v237
    v_fma_f32 v6, v6, v237, v237
    v_fma_f32 v7, v7, v237, v237
    v_rcp_f32 v4, v4
    v_rcp_f32 v5, v5
    v_rcp_f32 v6, v6
    v_rcp_f32 v7, v7
    v_mul_f32 v188, v188, v4
    v_mul_f32 v189, v189, v5
    v_mul_f32 v190, v190, v6
    v_mul_f32 v191, v191, v7
    s_lshl_b32 s50, s55, 6
    s_add_u32 s50, s50, s59
    v_cvt_pk_bf16_f32 v184, v184, v185
    v_cvt_pk_bf16_f32 v185, v186, v187
    v_cvt_pk_bf16_f32 v186, v188, v189
    v_cvt_pk_bf16_f32 v187, v190, v191
    s_nop 0
    v_permlane16_swap_b32 v184, v186
    v_permlane16_swap_b32 v185, v187
    buffer_store_dwordx4 v[184:187], v252, s[16:19], s50 offen sc1
    s_branch L_att
L_three:
    s_nop 1
    s_waitcnt vmcnt(0)
    v_mov_b32 v255, s32
    buffer_store_dword v255, v254, s[16:19], s62 offen sc1
    s_mov_b32 s62, 0x80000000
    v_mov_b32 v255, 163328
    v_mov_b32 v235, 1
    s_mov_b64 exec, 1
    ds_add_u32 v255, v235
    s_mov_b64 exec, -1
    s_mov_b32 s65, 0x80000
L_lw_26:
    ds_read_b32 v235, v255
    s_waitcnt lgkmcnt(0)
    v_cmp_gt_u32 vcc, 8, v235
    s_cbranch_vccz L_lwd_27
    s_sub_u32 s65, s65, 1
    s_cbranch_scc0 L_lw_26
    v_mov_b32 v235, 9
    v_mov_b32 v255, 0
    global_store_dword v255, v235, s[80:81]
L_lwd_27:
    s_branch L_att
L_d:
    s_setprio 0
    s_waitcnt vmcnt(0)
    v_cmp_ne_u32 vcc, s32, v247
    s_nop 0
    s_and_b32 vcc_hi, vcc_hi, 63
    s_mov_b64 vcc, vcc
    s_cbranch_vccz L_early_28
    s_mov_b32 s65, 0x10000
L_poll_29:
    buffer_load_dword v247, v241, s[16:19], 0 offen sc1
    s_waitcnt vmcnt(0)
    v_cmp_ne_u32 vcc, s32, v247
    s_nop 0
    s_and_b32 vcc_hi, vcc_hi, 63
    s_mov_b64 vcc, vcc
    s_cbranch_vccz L_polled_30
    s_sleep 1
    s_sub_u32 s65, s65, 1
    s_cbranch_scc0 L_poll_29
    v_mov_b32 v247, 3
    v_mov_b32 v255, 0
    global_store_dword v255, v247, s[80:81]
L_polled_30:
L_early_28:
    s_lshl_b32 s48, s34, 3
    s_add_u32 s48, s48, 0
    s_mul_i32 s48, s48, 40960
    s_add_u32 s44, s48, s86
    buffer_load_dwordx4 v[0:3], v246, s[16:19], s44 offen offset:0 sc1
    buffer_load_dwordx4 v[4:7], v246, s[16:19], s44 offen offset:1024 sc1
    buffer_load_dwordx4 v[8:11], v246, s[16:19], s44 offen offset:2048 sc1
    buffer_load_dwordx4 v[12:15], v246, s[16:19], s44 offen offset:3072 sc1
    s_add_u32 s44, s44, 4096
    buffer_load_dwordx4 v[16:19], v246, s[16:19], s44 offen sc1
    s_lshl_b32 s48, s34, 3
    s_add_u32 s48, s48, 1
    s_mul_i32 s48, s48, 40960
    s_add_u32 s44, s48, s86
    buffer_load_dwordx4 v[20:23], v246, s[16:19], s44 offen offset:0 sc1
    buffer_load_dwordx4 v[24:27], v246, s[16:19], s44 offen offset:1024 sc1
    buffer_load_dwordx4 v[28:31], v246, s[16:19], s44 offen offset:2048 sc1
    buffer_load_dwordx4 v[32:35], v246, s[16:19], s44 offen offset:3072 sc1
    s_add_u32 s44, s44, 4096
    buffer_load_dwordx4 v[36:39], v246, s[16:19], s44 offen sc1
    v_lshrrev_b32 v233, 8, v246
    v_and_b32 v234, 0xf0, v246
    v_lshl_add_u32 v244, v233, 11, v234
    s_add_u32 s49, s56, 162816
    v_add_u32 v255, s49, v253
    ds_read_b128 v[232:235], v255
    v_rcp_f32 v250, v249
    v_rcp_f32 v238, v237
    v_mul_f32 v250, 0xbfb8aa3b, v250
    v_mul_f32 v238, 0xbfb8aa3b, v238
    s_waitcnt lgkmcnt(0)
    v_fma_f32 v208, -v248, v232, v208
    v_fma_f32 v209, -v248, v233, v209
    v_fma_f32 v210, -v248, v234, v210
    v_fma_f32 v211, -v248, v235, v211
    v_fma_f32 v212, -v236, v232, v212
    v_fma_f32 v213, -v236, v233, v213
    v_fma_f32 v214, -v236, v234, v214
    v_fma_f32 v215, -v236, v235, v215
    s_add_u32 s49, s57, 162816
    v_add_u32 v255, s49, v253
    ds_read_b128 v[232:235], v255
    v_mul_f32 v239, v208, v250
    v_mul_f32 v251, v209, v250
    v_mul_f32 v245, v210, v250
    v_mul_f32 v247, v211, v250
    v_exp_f32 v239, v239
    v_exp_f32 v251, v251
    v_exp_f32 v245, v245
    v_exp_f32 v247, v247
    v_fma_f32 v239, v239, v249, v249
    v_fma_f32 v251, v251, v249, v249
    v_fma_f32 v245, v245, v249, v249
    v_fma_f32 v247, v247, v249, v249
    v_rcp_f32 v239, v239
    v_rcp_f32 v251, v251
    v_rcp_f32 v245, v245
    v_rcp_f32 v247, v247
    v_mul_f32 v208, v208, v239
    v_mul_f32 v209, v209, v251
    v_mul_f32 v210, v210, v245
    v_mul_f32 v211, v211, v247
    v_mul_f32 v239, v212, v238
    v_mul_f32 v251, v213, v238
    v_mul_f32 v245, v214, v238
    v_mul_f32 v247, v215, v238
    v_exp_f32 v239, v239
    v_exp_f32 v251, v251
    v_exp_f32 v245, v245
    v_exp_f32 v247, v247
    v_fma_f32 v239, v239, v237, v237
    v_fma_f32 v251, v251, v237, v237
    v_fma_f32 v245, v245, v237, v237
    v_fma_f32 v247, v247, v237, v237
    v_rcp_f32 v239, v239
    v_rcp_f32 v251, v251
    v_rcp_f32 v245, v245
    v_rcp_f32 v247, v247
    v_mul_f32 v212, v212, v239
    v_mul_f32 v213, v213, v251
    v_mul_f32 v214, v214, v245
    v_mul_f32 v215, v215, v247
    s_lshl_b32 s50, s56, 6
    s_add_u32 s50, s50, s59
    v_cvt_pk_bf16_f32 v208, v208, v209
    v_cvt_pk_bf16_f32 v209, v210, v211
    v_cvt_pk_bf16_f32 v210, v212, v213
    v_cvt_pk_bf16_f32 v211, v214, v215
    s_nop 0
    v_permlane16_swap_b32 v208, v210
    v_permlane16_swap_b32 v209, v211
    buffer_store_dwordx4 v[208:211], v252, s[16:19], s50 offen sc1
    s_waitcnt lgkmcnt(0)
    v_fma_f32 v216, -v248, v232, v216
    v_fma_f32 v217, -v248, v233, v217
    v_fma_f32 v218, -v248, v234, v218
    v_fma_f32 v219, -v248, v235, v219
    v_fma_f32 v220, -v236, v232, v220
    v_fma_f32 v221, -v236, v233, v221
    v_fma_f32 v222, -v236, v234, v222
    v_fma_f32 v223, -v236, v235, v223
    v_mul_f32 v239, v216, v250
    v_mul_f32 v251, v217, v250
    v_mul_f32 v245, v218, v250
    v_mul_f32 v247, v219, v250
    v_exp_f32 v239, v239
    v_exp_f32 v251, v251
    v_exp_f32 v245, v245
    v_exp_f32 v247, v247
    v_fma_f32 v239, v239, v249, v249
    v_fma_f32 v251, v251, v249, v249
    v_fma_f32 v245, v245, v249, v249
    v_fma_f32 v247, v247, v249, v249
    v_rcp_f32 v239, v239
    v_rcp_f32 v251, v251
    v_rcp_f32 v245, v245
    v_rcp_f32 v247, v247
    v_mul_f32 v216, v216, v239
    v_mul_f32 v217, v217, v251
    v_mul_f32 v218, v218, v245
    v_mul_f32 v219, v219, v247
    v_mul_f32 v239, v220, v238
    v_mul_f32 v251, v221, v238
    v_mul_f32 v245, v222, v238
    v_mul_f32 v247, v223, v238
    v_exp_f32 v239, v239
    v_exp_f32 v251, v251
    v_exp_f32 v245, v245
    v_exp_f32 v247, v247
    v_fma_f32 v239, v239, v237, v237
    v_fma_f32 v251, v251, v237, v237
    v_fma_f32 v245, v245, v237, v237
    v_fma_f32 v247, v247, v237, v237
    v_rcp_f32 v239, v239
    v_rcp_f32 v251, v251
    v_rcp_f32 v245, v245
    v_rcp_f32 v247, v247
    v_mul_f32 v220, v220, v239
    v_mul_f32 v221, v221, v251
    v_mul_f32 v222, v222, v245
    v_mul_f32 v223, v223, v247
    s_lshl_b32 s50, s57, 6
    s_add_u32 s50, s50, s59
    v_cvt_pk_bf16_f32 v216, v216, v217
    v_cvt_pk_bf16_f32 v217, v218, v219
    v_cvt_pk_bf16_f32 v218, v220, v221
    v_cvt_pk_bf16_f32 v219, v222, v223
    s_nop 0
    v_permlane16_swap_b32 v216, v218
    v_permlane16_swap_b32 v217, v219
    buffer_store_dwordx4 v[216:219], v252, s[16:19], s50 offen sc1
    s_setprio 0
    buffer_load_dword v243, v240, s[16:19], 0 offen sc1
    s_lshl_b32 s70, s34, 10
    v_add_u32 v100, s70, v246
    s_lshl_b32 s70, s36, 11
    v_add_u32 v101, s70, v100
    v_mov_b32 v102, 0xf149
    v_mov_b32 v227, 0
    v_cmp_gt_u32 vcc, 0x1000, v101
    v_add_u32 v100, 147456, v100
    s_nop 0
    v_cndmask_b32 v226, 0, v102, vcc
    ds_write_b128 v100, v[226:229]
    v_mov_b32 v104, 0
    v_mov_b32 v105, 0
    v_mov_b32 v106, v228
    v_mov_b32 v107, v228
    s_cmp_lt_u32 s34, 2
    s_cselect_b64 exec, -1, 0
    ds_write_b128 v100, v[104:107] offset:4096
    s_mov_b64 exec, -1
    s_waitcnt vmcnt(1)
    v_mov_b32 v255, s32
    buffer_store_dword v255, v254, s[16:19], s62 offen sc1
    s_waitcnt vmcnt(1)
    v_cmp_ne_u32 vcc, s32, v243
    s_cbranch_vccz L_early_31
    s_mov_b32 s65, 0x10000
L_poll_32:
    buffer_load_dword v243, v240, s[16:19], 0 offen sc1
    s_waitcnt vmcnt(0)
    v_cmp_ne_u32 vcc, s32, v243
    s_cbranch_vccz L_polled_33
    s_sleep 1
    s_sub_u32 s65, s65, 1
    s_cbranch_scc0 L_poll_32
    v_mov_b32 v243, 2
    v_mov_b32 v255, 0
    global_store_dword v255, v243, s[80:81]
L_polled_33:
L_early_31:
    s_sub_u32 s46, s63, 0
    s_add_u32 s47, s3, 4096
    s_mov_b32 m0, s47
    s_add_u32 s47, s47, s60
    buffer_load_dwordx4 v246, s[16:19], s46 offen sc1 lds
    s_add_u32 s46, s46, 2048
    s_mov_b32 m0, s47
    s_add_u32 s47, s47, s60
    buffer_load_dwordx4 v246, s[16:19], s46 offen sc1 lds
    s_add_u32 s46, s46, 2048
    s_mov_b32 m0, s47
    s_add_u32 s47, s47, s60
    buffer_load_dwordx4 v246, s[16:19], s46 offen sc1 lds
    s_add_u32 s46, s46, 2048
    s_mov_b32 m0, s47
    s_add_u32 s47, s47, s60
    buffer_load_dwordx4 v246, s[16:19], s46 offen sc1 lds
    s_add_u32 s46, s46, 2048
    s_mov_b32 m0, s47
    s_add_u32 s47, s47, s60
    buffer_load_dwordx4 v246, s[16:19], s46 offen sc1 lds
    s_sub_u32 s46, s63, 491520
    s_cmp_ge_u32 s36, 1
    s_cselect_b32 s46, s46, 0x80000000
    s_add_u32 s47, s3, 2048
    s_mov_b32 m0, s47
    s_add_u32 s47, s47, s60
    buffer_load_dwordx4 v246, s[16:19], s46 offen sc1 lds
    s_add_u32 s46, s46, 2048
    s_mov_b32 m0, s47
    s_add_u32 s47, s47, s60
    buffer_load_dwordx4 v246, s[16:19], s46 offen sc1 lds
    s_add_u32 s46, s46, 2048
    s_mov_b32 m0, s47
    s_add_u32 s47, s47, s60
    buffer_load_dwordx4 v246, s[16:19], s46 offen sc1 lds
    s_add_u32 s46, s46, 2048
    s_mov_b32 m0, s47
    s_add_u32 s47, s47, s60
    buffer_load_dwordx4 v246, s[16:19], s46 offen sc1 lds
    s_add_u32 s46, s46, 2048
    s_mov_b32 m0, s47
    s_add_u32 s47, s47, s60
    buffer_load_dwordx4 v246, s[16:19], s46 offen sc1 lds
    s_sub_u32 s46, s63, 983040
    s_cmp_ge_u32 s36, 2
    s_cselect_b32 s46, s46, 0x80000000
    s_add_u32 s47, s3, 0
    s_mov_b32 m0, s47
    s_add_u32 s47, s47, s60
    buffer_load_dwordx4 v246, s[16:19], s46 offen sc1 lds
    s_add_u32 s46, s46, 2048
    s_mov_b32 m0, s47
    s_add_u32 s47, s47, s60
    buffer_load_dwordx4 v246, s[16:19], s46 offen sc1 lds
    s_add_u32 s46, s46, 2048
    s_mov_b32 m0, s47
    s_add_u32 s47, s47, s60
    buffer_load_dwordx4 v246, s[16:19], s46 offen sc1 lds
    s_add_u32 s46, s46, 2048
    s_mov_b32 m0, s47
    s_add_u32 s47, s47, s60
    buffer_load_dwordx4 v246, s[16:19], s46 offen sc1 lds
    s_add_u32 s46, s46, 2048
    s_mov_b32 m0, s47
    s_add_u32 s47, s47, s60
    buffer_load_dwordx4 v246, s[16:19], s46 offen sc1 lds
    s_lshr_b32 s48, s34, 1
    s_mul_i32 s46, s48, 157696
    s_sub_u32 s46, s63, s46
    s_sub_u32 s46, s46, 163840
    s_and_b32 s47, s34, 1
    s_lshl_b32 s47, s47, 10
    s_mov_b32 s70, 159744
    s_cmp_eq_u32 s48, 0
    s_cselect_b32 s70, 153600, s70
    s_add_u32 m0, s70, s47
    s_nop 0
    buffer_load_dwordx4 v246, s[16:19], s46 offen sc1 lds
    s_add_u32 s46, s46, 2048
    s_mov_b32 s70, 79872
    s_cmp_eq_u32 s48, 0
    s_cselect_b32 s70, 155648, s70
    s_add_u32 m0, s70, s47
    s_nop 0
    buffer_load_dwordx4 v246, s[16:19], s46 offen sc1 lds
    s_add_u32 s46, s46, 2048
    s_mov_b32 s70, 79872
    s_cmp_eq_u32 s48, 0
    s_cselect_b32 s70, 157696, s70
    s_cselect_b64 exec, -1, 0
    s_add_u32 m0, s70, s47
    s_nop 0
    buffer_load_dwordx4 v246, s[16:19], s46 offen sc1 lds
    s_add_u32 s46, s46, 2048
    s_mov_b64 exec, -1
    s_lshl_b32 s48, s34, 3
    s_add_u32 s48, s48, 2
    s_mul_i32 s48, s48, 40960
    s_add_u32 s44, s48, s86
    buffer_load_dwordx4 v[40:43], v246, s[16:19], s44 offen offset:0 sc1
    buffer_load_dwordx4 v[44:47], v246, s[16:19], s44 offen offset:1024 sc1
    buffer_load_dwordx4 v[48:51], v246, s[16:19], s44 offen offset:2048 sc1
    buffer_load_dwordx4 v[52:55], v246, s[16:19], s44 offen offset:3072 sc1
    s_add_u32 s44, s44, 4096
    buffer_load_dwordx4 v[56:59], v246, s[16:19], s44 offen sc1
    s_waitcnt vmcnt(5)
    v_mov_b32 v255, 163328
    v_mov_b32 v108, 1
    s_mov_b64 exec, 1
    ds_add_u32 v255, v108
    s_mov_b64 exec, -1
    buffer_load_dword v235, v241, s[16:19], 0 offen sc1
    s_lshl_b32 s48, s34, 3
    s_add_u32 s48, s48, 3
    s_mul_i32 s48, s48, 40960
    s_add_u32 s44, s48, s86
    buffer_load_dwordx4 v[60:63], v246, s[16:19], s44 offen offset:0 sc1
    buffer_load_dwordx4 v[64:67], v246, s[16:19], s44 offen offset:1024 sc1
    buffer_load_dwordx4 v[68:71], v246, s[16:19], s44 offen offset:2048 sc1
    buffer_load_dwordx4 v[72:75], v246, s[16:19], s44 offen offset:3072 sc1
    s_add_u32 s44, s44, 4096
    buffer_load_dwordx4 v[76:79], v246, s[16:19], s44 offen sc1
    s_lshl_b32 s48, s34, 3
    s_add_u32 s48, s48, 4
    s_mul_i32 s48, s48, 40960
    s_add_u32 s44, s48, s86
    buffer_load_dwordx4 v[80:83], v246, s[16:19], s44 offen offset:0 sc1
    buffer_load_dwordx4 v[84:87], v246, s[16:19], s44 offen offset:1024 sc1
    buffer_load_dwordx4 v[88:91], v246, s[16:19], s44 offen offset:2048 sc1
    buffer_load_dwordx4 v[92:95], v246, s[16:19], s44 offen offset:3072 sc1
    s_add_u32 s44, s44, 4096
    buffer_load_dwordx4 v[96:99], v246, s[16:19], s44 offen sc1
    s_waitcnt vmcnt(10)
    v_cmp_ne_u32 vcc, s32, v235
    s_cbranch_vccz L_early_34
    s_mov_b32 s65, 0x10000
L_poll_35:
    buffer_load_dword v235, v241, s[16:19], 0 offen sc1
    s_waitcnt vmcnt(0)
    v_cmp_ne_u32 vcc, s32, v235
    s_cbranch_vccz L_polled_36
    s_sleep 1
    s_sub_u32 s65, s65, 1
    s_cbranch_scc0 L_poll_35
    v_mov_b32 v235, 4
    v_mov_b32 v255, 0
    global_store_dword v255, v235, s[80:81]
L_polled_36:
L_early_34:
    s_lshl_b32 s48, s34, 3
    s_add_u32 s48, s48, 0
    s_mul_i32 s48, s48, 8192
    s_add_u32 s45, s48, s87
    buffer_load_dwordx4 v[100:103], v244, s[16:19], s45 offen offset:0 sc1
    buffer_load_dwordx4 v[104:107], v244, s[16:19], s45 offen offset:256 sc1
    buffer_load_dwordx4 v[108:111], v244, s[16:19], s45 offen offset:512 sc1
    buffer_load_dwordx4 v[112:115], v244, s[16:19], s45 offen offset:768 sc1
    s_lshl_b32 s48, s34, 3
    s_add_u32 s48, s48, 1
    s_mul_i32 s48, s48, 8192
    s_add_u32 s45, s48, s87
    buffer_load_dwordx4 v[116:119], v244, s[16:19], s45 offen offset:0 sc1
    buffer_load_dwordx4 v[120:123], v244, s[16:19], s45 offen offset:256 sc1
    buffer_load_dwordx4 v[124:127], v244, s[16:19], s45 offen offset:512 sc1
    buffer_load_dwordx4 v[128:131], v244, s[16:19], s45 offen offset:768 sc1
    s_lshl_b32 s48, s34, 3
    s_add_u32 s48, s48, 2
    s_mul_i32 s48, s48, 8192
    s_add_u32 s45, s48, s87
    buffer_load_dwordx4 v[132:135], v244, s[16:19], s45 offen offset:0 sc1
    buffer_load_dwordx4 v[136:139], v244, s[16:19], s45 offen offset:256 sc1
    buffer_load_dwordx4 v[140:143], v244, s[16:19], s45 offen offset:512 sc1
    buffer_load_dwordx4 v[144:147], v244, s[16:19], s45 offen offset:768 sc1
    v_lshrrev_b32 v249, 4, v246
    s_waitcnt vmcnt(8)
    v_mfma_f32_16x16x32_bf16 v[164:167], v[0:3], v[100:103], 0
    v_mfma_f32_16x16x32_bf16 v[184:187], v[0:3], v[104:107], 0
    s_lshl_b32 s48, s34, 3
    s_add_u32 s48, s48, 3
    s_mul_i32 s48, s48, 8192
    s_add_u32 s45, s48, s87
    buffer_load_dwordx4 v[148:151], v244, s[16:19], s45 offen offset:0 sc1
    v_mfma_f32_16x16x32_bf16 v[204:207], v[0:3], v[108:111], 0
    v_mfma_f32_16x16x32_bf16 v[224:227], v[0:3], v[112:115], 0
    s_lshl_b32 s48, s34, 3
    s_add_u32 s48, s48, 5
    s_mul_i32 s48, s48, 40960
    s_add_u32 s44, s48, s86
    buffer_load_dwordx4 v[0:3], v246, s[16:19], s44 offen offset:0 sc1
    v_mfma_f32_16x16x32_bf16 v[168:171], v[4:7], v[100:103], 0
    v_mfma_f32_16x16x32_bf16 v[188:191], v[4:7], v[104:107], 0
    buffer_load_dwordx4 v[152:155], v244, s[16:19], s45 offen offset:256 sc1
    v_mfma_f32_16x16x32_bf16 v[208:211], v[4:7], v[108:111], 0
    v_mfma_f32_16x16x32_bf16 v[228:231], v[4:7], v[112:115], 0
    buffer_load_dwordx4 v[4:7], v246, s[16:19], s44 offen offset:1024 sc1
    v_mfma_f32_16x16x32_bf16 v[172:175], v[8:11], v[100:103], 0
    v_mfma_f32_16x16x32_bf16 v[192:195], v[8:11], v[104:107], 0
    buffer_load_dwordx4 v[156:159], v244, s[16:19], s45 offen offset:512 sc1
    v_mfma_f32_16x16x32_bf16 v[212:215], v[8:11], v[108:111], 0
    v_mfma_f32_16x16x32_bf16 v[232:235], v[8:11], v[112:115], 0
    buffer_load_dwordx4 v[8:11], v246, s[16:19], s44 offen offset:2048 sc1
    v_mfma_f32_16x16x32_bf16 v[176:179], v[12:15], v[100:103], 0
    v_mfma_f32_16x16x32_bf16 v[196:199], v[12:15], v[104:107], 0
    buffer_load_dwordx4 v[160:163], v244, s[16:19], s45 offen offset:768 sc1
    v_mfma_f32_16x16x32_bf16 v[216:219], v[12:15], v[108:111], 0
    v_mfma_f32_16x16x32_bf16 v[236:239], v[12:15], v[112:115], 0
    buffer_load_dwordx4 v[12:15], v246, s[16:19], s44 offen offset:3072 sc1
    v_mfma_f32_16x16x32_bf16 v[180:183], v[16:19], v[100:103], 0
    v_mfma_f32_16x16x32_bf16 v[200:203], v[16:19], v[104:107], 0
    v_mfma_f32_16x16x32_bf16 v[220:223], v[16:19], v[108:111], 0
    v_mfma_f32_16x16x32_bf16 v[240:243], v[16:19], v[112:115], 0
    s_add_u32 s44, s44, 4096
    buffer_load_dwordx4 v[16:19], v246, s[16:19], s44 offen sc1
    s_waitcnt vmcnt(13)
    v_mfma_f32_16x16x32_bf16 v[164:167], v[20:23], v[116:119], v[164:167]
    v_mfma_f32_16x16x32_bf16 v[184:187], v[20:23], v[120:123], v[184:187]
    s_lshl_b32 s48, s34, 3
    s_add_u32 s48, s48, 4
    s_mul_i32 s48, s48, 8192
    s_add_u32 s45, s48, s87
    buffer_load_dwordx4 v[100:103], v244, s[16:19], s45 offen offset:0 sc1
    v_mfma_f32_16x16x32_bf16 v[204:207], v[20:23], v[124:127], v[204:207]
    v_mfma_f32_16x16x32_bf16 v[224:227], v[20:23], v[128:131], v[224:227]
    s_lshl_b32 s48, s34, 3
    s_add_u32 s48, s48, 6
    s_mul_i32 s48, s48, 40960
    s_add_u32 s44, s48, s86
    buffer_load_dwordx4 v[20:23], v246, s[16:19], s44 offen offset:0 sc1
    v_mfma_f32_16x16x32_bf16 v[168:171], v[24:27], v[116:119], v[168:171]
    v_mfma_f32_16x16x32_bf16 v[188:191], v[24:27], v[120:123], v[188:191]
    buffer_load_dwordx4 v[104:107], v244, s[16:19], s45 offen offset:256 sc1
    v_mfma_f32_16x16x32_bf16 v[208:211], v[24:27], v[124:127], v[208:211]
    v_mfma_f32_16x16x32_bf16 v[228:231], v[24:27], v[128:131], v[228:231]
    buffer_load_dwordx4 v[24:27], v246, s[16:19], s44 offen offset:1024 sc1
    v_mfma_f32_16x16x32_bf16 v[172:175], v[28:31], v[116:119], v[172:175]
    v_mfma_f32_16x16x32_bf16 v[192:195], v[28:31], v[120:123], v[192:195]
    buffer_load_dwordx4 v[108:111], v244, s[16:19], s45 offen offset:512 sc1
    v_mfma_f32_16x16x32_bf16 v[212:215], v[28:31], v[124:127], v[212:215]
    v_mfma_f32_16x16x32_bf16 v[232:235], v[28:31], v[128:131], v[232:235]
    buffer_load_dwordx4 v[28:31], v246, s[16:19], s44 offen offset:2048 sc1
    v_mfma_f32_16x16x32_bf16 v[176:179], v[32:35], v[116:119], v[176:179]
    v_mfma_f32_16x16x32_bf16 v[196:199], v[32:35], v[120:123], v[196:199]
    buffer_load_dwordx4 v[112:115], v244, s[16:19], s45 offen offset:768 sc1
    v_mfma_f32_16x16x32_bf16 v[216:219], v[32:35], v[124:127], v[216:219]
    v_mfma_f32_16x16x32_bf16 v[236:239], v[32:35], v[128:131], v[236:239]
    buffer_load_dwordx4 v[32:35], v246, s[16:19], s44 offen offset:3072 sc1
    v_mfma_f32_16x16x32_bf16 v[180:183], v[36:39], v[116:119], v[180:183]
    v_mfma_f32_16x16x32_bf16 v[200:203], v[36:39], v[120:123], v[200:203]
    v_mfma_f32_16x16x32_bf16 v[220:223], v[36:39], v[124:127], v[220:223]
    v_mfma_f32_16x16x32_bf16 v[240:243], v[36:39], v[128:131], v[240:243]
    s_add_u32 s44, s44, 4096
    buffer_load_dwordx4 v[36:39], v246, s[16:19], s44 offen sc1
    s_waitcnt vmcnt(18)
    v_mfma_f32_16x16x32_bf16 v[164:167], v[40:43], v[132:135], v[164:167]
    v_mfma_f32_16x16x32_bf16 v[184:187], v[40:43], v[136:139], v[184:187]
    s_lshl_b32 s48, s34, 3
    s_add_u32 s48, s48, 5
    s_mul_i32 s48, s48, 8192
    s_add_u32 s45, s48, s87
    buffer_load_dwordx4 v[116:119], v244, s[16:19], s45 offen offset:0 sc1
    v_mfma_f32_16x16x32_bf16 v[204:207], v[40:43], v[140:143], v[204:207]
    v_mfma_f32_16x16x32_bf16 v[224:227], v[40:43], v[144:147], v[224:227]
    s_lshl_b32 s48, s34, 3
    s_add_u32 s48, s48, 7
    s_mul_i32 s48, s48, 40960
    s_add_u32 s44, s48, s86
    buffer_load_dwordx4 v[40:43], v246, s[16:19], s44 offen offset:0 sc1
    v_mfma_f32_16x16x32_bf16 v[168:171], v[44:47], v[132:135], v[168:171]
    v_mfma_f32_16x16x32_bf16 v[188:191], v[44:47], v[136:139], v[188:191]
    buffer_load_dwordx4 v[120:123], v244, s[16:19], s45 offen offset:256 sc1
    v_mfma_f32_16x16x32_bf16 v[208:211], v[44:47], v[140:143], v[208:211]
    v_mfma_f32_16x16x32_bf16 v[228:231], v[44:47], v[144:147], v[228:231]
    buffer_load_dwordx4 v[44:47], v246, s[16:19], s44 offen offset:1024 sc1
    v_mfma_f32_16x16x32_bf16 v[172:175], v[48:51], v[132:135], v[172:175]
    v_mfma_f32_16x16x32_bf16 v[192:195], v[48:51], v[136:139], v[192:195]
    buffer_load_dwordx4 v[124:127], v244, s[16:19], s45 offen offset:512 sc1
    v_mfma_f32_16x16x32_bf16 v[212:215], v[48:51], v[140:143], v[212:215]
    v_mfma_f32_16x16x32_bf16 v[232:235], v[48:51], v[144:147], v[232:235]
    buffer_load_dwordx4 v[48:51], v246, s[16:19], s44 offen offset:2048 sc1
    v_mfma_f32_16x16x32_bf16 v[176:179], v[52:55], v[132:135], v[176:179]
    v_mfma_f32_16x16x32_bf16 v[196:199], v[52:55], v[136:139], v[196:199]
    buffer_load_dwordx4 v[128:131], v244, s[16:19], s45 offen offset:768 sc1
    v_mfma_f32_16x16x32_bf16 v[216:219], v[52:55], v[140:143], v[216:219]
    v_mfma_f32_16x16x32_bf16 v[236:239], v[52:55], v[144:147], v[236:239]
    buffer_load_dwordx4 v[52:55], v246, s[16:19], s44 offen offset:3072 sc1
    v_mfma_f32_16x16x32_bf16 v[180:183], v[56:59], v[132:135], v[180:183]
    v_mfma_f32_16x16x32_bf16 v[200:203], v[56:59], v[136:139], v[200:203]
    v_mfma_f32_16x16x32_bf16 v[220:223], v[56:59], v[140:143], v[220:223]
    v_mfma_f32_16x16x32_bf16 v[240:243], v[56:59], v[144:147], v[240:243]
    s_add_u32 s44, s44, 4096
    buffer_load_dwordx4 v[56:59], v246, s[16:19], s44 offen sc1
    s_waitcnt vmcnt(20)
    v_mfma_f32_16x16x32_bf16 v[164:167], v[60:63], v[148:151], v[164:167]
    v_mfma_f32_16x16x32_bf16 v[184:187], v[60:63], v[152:155], v[184:187]
    s_lshl_b32 s48, s34, 3
    s_add_u32 s48, s48, 6
    s_mul_i32 s48, s48, 8192
    s_add_u32 s45, s48, s87
    buffer_load_dwordx4 v[132:135], v244, s[16:19], s45 offen offset:0 sc1
    v_mfma_f32_16x16x32_bf16 v[204:207], v[60:63], v[156:159], v[204:207]
    v_mfma_f32_16x16x32_bf16 v[224:227], v[60:63], v[160:163], v[224:227]
    s_add_u32 s48, s89, 0
    s_mul_i32 s48, s48, 40960
    s_add_u32 s44, s48, s86
    buffer_load_dwordx4 v[60:63], v246, s[16:19], s44 offen offset:0 sc1
    v_mfma_f32_16x16x32_bf16 v[168:171], v[64:67], v[148:151], v[168:171]
    v_mfma_f32_16x16x32_bf16 v[188:191], v[64:67], v[152:155], v[188:191]
    buffer_load_dwordx4 v[136:139], v244, s[16:19], s45 offen offset:256 sc1
    v_mfma_f32_16x16x32_bf16 v[208:211], v[64:67], v[156:159], v[208:211]
    v_mfma_f32_16x16x32_bf16 v[228:231], v[64:67], v[160:163], v[228:231]
    buffer_load_dwordx4 v[64:67], v246, s[16:19], s44 offen offset:1024 sc1
    v_mfma_f32_16x16x32_bf16 v[172:175], v[68:71], v[148:151], v[172:175]
    v_mfma_f32_16x16x32_bf16 v[192:195], v[68:71], v[152:155], v[192:195]
    buffer_load_dwordx4 v[140:143], v244, s[16:19], s45 offen offset:512 sc1
    v_mfma_f32_16x16x32_bf16 v[212:215], v[68:71], v[156:159], v[212:215]
    v_mfma_f32_16x16x32_bf16 v[232:235], v[68:71], v[160:163], v[232:235]
    buffer_load_dwordx4 v[68:71], v246, s[16:19], s44 offen offset:2048 sc1
    v_mfma_f32_16x16x32_bf16 v[176:179], v[72:75], v[148:151], v[176:179]
    v_mfma_f32_16x16x32_bf16 v[196:199], v[72:75], v[152:155], v[196:199]
    buffer_load_dwordx4 v[144:147], v244, s[16:19], s45 offen offset:768 sc1
    v_mfma_f32_16x16x32_bf16 v[216:219], v[72:75], v[156:159], v[216:219]
    v_mfma_f32_16x16x32_bf16 v[236:239], v[72:75], v[160:163], v[236:239]
    buffer_load_dwordx4 v[72:75], v246, s[16:19], s44 offen offset:3072 sc1
    v_mfma_f32_16x16x32_bf16 v[180:183], v[76:79], v[148:151], v[180:183]
    v_mfma_f32_16x16x32_bf16 v[200:203], v[76:79], v[152:155], v[200:203]
    v_mfma_f32_16x16x32_bf16 v[220:223], v[76:79], v[156:159], v[220:223]
    v_mfma_f32_16x16x32_bf16 v[240:243], v[76:79], v[160:163], v[240:243]
    s_add_u32 s44, s44, 4096
    buffer_load_dwordx4 v[76:79], v246, s[16:19], s44 offen sc1
    s_lshr_b32 s47, s34, 1
    s_sub_u32 s47, 5, s47
    v_lshrrev_b32 v250, 1, v249
    v_min_u32 v250, s47, v250
    v_add_u32 v250, s89, v250
    v_lshrrev_b32 v251, 1, v250
    s_lshl_b32 s48, s84, 5
    v_add_u32 v251, s48, v251
    v_lshlrev_b32 v251, 7, v251
    v_and_b32 v250, 1, v250
    v_lshl_add_u32 v251, v250, 4, v251
    v_and_b32 v250, 1, v249
    v_lshl_add_u32 v251, v250, 2, v251
    s_lshl_b32 s48, s85, 3
    s_add_u32 s48, s48, 0x11000
    v_add_u32 v247, s48, v251
    buffer_load_dword v248, v247, s[16:19], 0 offen sc1
    s_waitcnt vmcnt(21)
    v_mfma_f32_16x16x32_bf16 v[164:167], v[80:83], v[100:103], v[164:167]
    v_mfma_f32_16x16x32_bf16 v[184:187], v[80:83], v[104:107], v[184:187]
    s_lshl_b32 s48, s34, 3
    s_add_u32 s48, s48, 7
    s_mul_i32 s48, s48, 8192
    s_add_u32 s45, s48, s87
    buffer_load_dwordx4 v[148:151], v244, s[16:19], s45 offen offset:0 sc1
    v_mfma_f32_16x16x32_bf16 v[204:207], v[80:83], v[108:111], v[204:207]
    v_mfma_f32_16x16x32_bf16 v[224:227], v[80:83], v[112:115], v[224:227]
    s_add_u32 s48, s89, 1
    s_mul_i32 s48, s48, 40960
    s_add_u32 s44, s48, s86
    buffer_load_dwordx4 v[80:83], v246, s[16:19], s44 offen offset:0 sc1
    v_mfma_f32_16x16x32_bf16 v[168:171], v[84:87], v[100:103], v[168:171]
    v_mfma_f32_16x16x32_bf16 v[188:191], v[84:87], v[104:107], v[188:191]
    buffer_load_dwordx4 v[152:155], v244, s[16:19], s45 offen offset:256 sc1
    v_mfma_f32_16x16x32_bf16 v[208:211], v[84:87], v[108:111], v[208:211]
    v_mfma_f32_16x16x32_bf16 v[228:231], v[84:87], v[112:115], v[228:231]
    buffer_load_dwordx4 v[84:87], v246, s[16:19], s44 offen offset:1024 sc1
    v_mfma_f32_16x16x32_bf16 v[172:175], v[88:91], v[100:103], v[172:175]
    v_mfma_f32_16x16x32_bf16 v[192:195], v[88:91], v[104:107], v[192:195]
    buffer_load_dwordx4 v[156:159], v244, s[16:19], s45 offen offset:512 sc1
    v_mfma_f32_16x16x32_bf16 v[212:215], v[88:91], v[108:111], v[212:215]
    v_mfma_f32_16x16x32_bf16 v[232:235], v[88:91], v[112:115], v[232:235]
    buffer_load_dwordx4 v[88:91], v246, s[16:19], s44 offen offset:2048 sc1
    v_mfma_f32_16x16x32_bf16 v[176:179], v[92:95], v[100:103], v[176:179]
    v_mfma_f32_16x16x32_bf16 v[196:199], v[92:95], v[104:107], v[196:199]
    buffer_load_dwordx4 v[160:163], v244, s[16:19], s45 offen offset:768 sc1
    v_mfma_f32_16x16x32_bf16 v[216:219], v[92:95], v[108:111], v[216:219]
    v_mfma_f32_16x16x32_bf16 v[236:239], v[92:95], v[112:115], v[236:239]
    buffer_load_dwordx4 v[92:95], v246, s[16:19], s44 offen offset:3072 sc1
    v_mfma_f32_16x16x32_bf16 v[180:183], v[96:99], v[100:103], v[180:183]
    v_mfma_f32_16x16x32_bf16 v[200:203], v[96:99], v[104:107], v[200:203]
    v_mfma_f32_16x16x32_bf16 v[220:223], v[96:99], v[108:111], v[220:223]
    v_mfma_f32_16x16x32_bf16 v[240:243], v[96:99], v[112:115], v[240:243]
    s_add_u32 s44, s44, 4096
    buffer_load_dwordx4 v[96:99], v246, s[16:19], s44 offen sc1
    s_waitcnt vmcnt(9)
    v_cmp_ne_u32 vcc, s32, v248
    s_cbranch_vccz L_early_37
    s_mov_b32 s65, 0x10000
L_poll_38:
    buffer_load_dword v248, v247, s[16:19], 0 offen sc1
    s_waitcnt vmcnt(0)
    v_cmp_ne_u32 vcc, s32, v248
    s_cbranch_vccz L_polled_39
    s_sleep 1
    s_sub_u32 s65, s65, 1
    s_cbranch_scc0 L_poll_38
    v_mov_b32 v248, 5
    v_mov_b32 v255, 0
    global_store_dword v255, v248, s[80:81]
L_polled_39:
L_early_37:
    v_mfma_f32_16x16x32_bf16 v[164:167], v[0:3], v[116:119], v[164:167]
    v_mfma_f32_16x16x32_bf16 v[184:187], v[0:3], v[120:123], v[184:187]
    s_add_u32 s48, s89, 0
    s_mul_i32 s48, s48, 8192
    s_add_u32 s45, s48, s87
    buffer_load_dwordx4 v[100:103], v244, s[16:19], s45 offen offset:0 sc1
    v_mfma_f32_16x16x32_bf16 v[204:207], v[0:3], v[124:127], v[204:207]
    v_mfma_f32_16x16x32_bf16 v[224:227], v[0:3], v[128:131], v[224:227]
    s_add_u32 s48, s89, 2
    s_mul_i32 s48, s48, 40960
    s_add_u32 s44, s48, s86
    buffer_load_dwordx4 v[0:3], v246, s[16:19], s44 offen offset:0 sc1
    v_mfma_f32_16x16x32_bf16 v[168:171], v[4:7], v[116:119], v[168:171]
    v_mfma_f32_16x16x32_bf16 v[188:191], v[4:7], v[120:123], v[188:191]
    buffer_load_dwordx4 v[104:107], v244, s[16:19], s45 offen offset:256 sc1
    v_mfma_f32_16x16x32_bf16 v[208:211], v[4:7], v[124:127], v[208:211]
    v_mfma_f32_16x16x32_bf16 v[228:231], v[4:7], v[128:131], v[228:231]
    buffer_load_dwordx4 v[4:7], v246, s[16:19], s44 offen offset:1024 sc1
    v_mfma_f32_16x16x32_bf16 v[172:175], v[8:11], v[116:119], v[172:175]
    v_mfma_f32_16x16x32_bf16 v[192:195], v[8:11], v[120:123], v[192:195]
    buffer_load_dwordx4 v[108:111], v244, s[16:19], s45 offen offset:512 sc1
    v_mfma_f32_16x16x32_bf16 v[212:215], v[8:11], v[124:127], v[212:215]
    v_mfma_f32_16x16x32_bf16 v[232:235], v[8:11], v[128:131], v[232:235]
    buffer_load_dwordx4 v[8:11], v246, s[16:19], s44 offen offset:2048 sc1
    v_mfma_f32_16x16x32_bf16 v[176:179], v[12:15], v[116:119], v[176:179]
    v_mfma_f32_16x16x32_bf16 v[196:199], v[12:15], v[120:123], v[196:199]
    buffer_load_dwordx4 v[112:115], v244, s[16:19], s45 offen offset:768 sc1
    v_mfma_f32_16x16x32_bf16 v[216:219], v[12:15], v[124:127], v[216:219]
    v_mfma_f32_16x16x32_bf16 v[236:239], v[12:15], v[128:131], v[236:239]
    buffer_load_dwordx4 v[12:15], v246, s[16:19], s44 offen offset:3072 sc1
    v_mfma_f32_16x16x32_bf16 v[180:183], v[16:19], v[116:119], v[180:183]
    v_mfma_f32_16x16x32_bf16 v[200:203], v[16:19], v[120:123], v[200:203]
    v_mfma_f32_16x16x32_bf16 v[220:223], v[16:19], v[124:127], v[220:223]
    v_mfma_f32_16x16x32_bf16 v[240:243], v[16:19], v[128:131], v[240:243]
    s_add_u32 s44, s44, 4096
    buffer_load_dwordx4 v[16:19], v246, s[16:19], s44 offen sc1
    v_mfma_f32_16x16x32_bf16 v[164:167], v[20:23], v[132:135], v[164:167]
    v_mfma_f32_16x16x32_bf16 v[184:187], v[20:23], v[136:139], v[184:187]
    s_add_u32 s48, s89, 1
    s_mul_i32 s48, s48, 8192
    s_add_u32 s45, s48, s87
    buffer_load_dwordx4 v[116:119], v244, s[16:19], s45 offen offset:0 sc1
    v_mfma_f32_16x16x32_bf16 v[204:207], v[20:23], v[140:143], v[204:207]
    v_mfma_f32_16x16x32_bf16 v[224:227], v[20:23], v[144:147], v[224:227]
    s_add_u32 s48, s89, 3
    s_mul_i32 s48, s48, 40960
    s_add_u32 s44, s48, s86
    buffer_load_dwordx4 v[20:23], v246, s[16:19], s44 offen offset:0 sc1
    v_mfma_f32_16x16x32_bf16 v[168:171], v[24:27], v[132:135], v[168:171]
    v_mfma_f32_16x16x32_bf16 v[188:191], v[24:27], v[136:139], v[188:191]
    buffer_load_dwordx4 v[120:123], v244, s[16:19], s45 offen offset:256 sc1
    v_mfma_f32_16x16x32_bf16 v[208:211], v[24:27], v[140:143], v[208:211]
    v_mfma_f32_16x16x32_bf16 v[228:231], v[24:27], v[144:147], v[228:231]
    buffer_load_dwordx4 v[24:27], v246, s[16:19], s44 offen offset:1024 sc1
    v_mfma_f32_16x16x32_bf16 v[172:175], v[28:31], v[132:135], v[172:175]
    v_mfma_f32_16x16x32_bf16 v[192:195], v[28:31], v[136:139], v[192:195]
    buffer_load_dwordx4 v[124:127], v244, s[16:19], s45 offen offset:512 sc1
    v_mfma_f32_16x16x32_bf16 v[212:215], v[28:31], v[140:143], v[212:215]
    v_mfma_f32_16x16x32_bf16 v[232:235], v[28:31], v[144:147], v[232:235]
    buffer_load_dwordx4 v[28:31], v246, s[16:19], s44 offen offset:2048 sc1
    v_mfma_f32_16x16x32_bf16 v[176:179], v[32:35], v[132:135], v[176:179]
    v_mfma_f32_16x16x32_bf16 v[196:199], v[32:35], v[136:139], v[196:199]
    buffer_load_dwordx4 v[128:131], v244, s[16:19], s45 offen offset:768 sc1
    v_mfma_f32_16x16x32_bf16 v[216:219], v[32:35], v[140:143], v[216:219]
    v_mfma_f32_16x16x32_bf16 v[236:239], v[32:35], v[144:147], v[236:239]
    buffer_load_dwordx4 v[32:35], v246, s[16:19], s44 offen offset:3072 sc1
    v_mfma_f32_16x16x32_bf16 v[180:183], v[36:39], v[132:135], v[180:183]
    v_mfma_f32_16x16x32_bf16 v[200:203], v[36:39], v[136:139], v[200:203]
    v_mfma_f32_16x16x32_bf16 v[220:223], v[36:39], v[140:143], v[220:223]
    v_mfma_f32_16x16x32_bf16 v[240:243], v[36:39], v[144:147], v[240:243]
    s_add_u32 s44, s44, 4096
    buffer_load_dwordx4 v[36:39], v246, s[16:19], s44 offen sc1
    s_waitcnt vmcnt(20)
    v_mfma_f32_16x16x32_bf16 v[164:167], v[40:43], v[148:151], v[164:167]
    v_mfma_f32_16x16x32_bf16 v[184:187], v[40:43], v[152:155], v[184:187]
    s_add_u32 s48, s89, 2
    s_mul_i32 s48, s48, 8192
    s_add_u32 s45, s48, s87
    buffer_load_dwordx4 v[132:135], v244, s[16:19], s45 offen offset:0 sc1
    v_mfma_f32_16x16x32_bf16 v[204:207], v[40:43], v[156:159], v[204:207]
    v_mfma_f32_16x16x32_bf16 v[224:227], v[40:43], v[160:163], v[224:227]
    s_add_u32 s48, s89, 4
    s_mul_i32 s48, s48, 40960
    s_add_u32 s44, s48, s86
    buffer_load_dwordx4 v[40:43], v246, s[16:19], s44 offen offset:0 sc1
    v_mfma_f32_16x16x32_bf16 v[168:171], v[44:47], v[148:151], v[168:171]
    v_mfma_f32_16x16x32_bf16 v[188:191], v[44:47], v[152:155], v[188:191]
    buffer_load_dwordx4 v[136:139], v244, s[16:19], s45 offen offset:256 sc1
    v_mfma_f32_16x16x32_bf16 v[208:211], v[44:47], v[156:159], v[208:211]
    v_mfma_f32_16x16x32_bf16 v[228:231], v[44:47], v[160:163], v[228:231]
    buffer_load_dwordx4 v[44:47], v246, s[16:19], s44 offen offset:1024 sc1
    v_mfma_f32_16x16x32_bf16 v[172:175], v[48:51], v[148:151], v[172:175]
    v_mfma_f32_16x16x32_bf16 v[192:195], v[48:51], v[152:155], v[192:195]
    buffer_load_dwordx4 v[140:143], v244, s[16:19], s45 offen offset:512 sc1
    v_mfma_f32_16x16x32_bf16 v[212:215], v[48:51], v[156:159], v[212:215]
    v_mfma_f32_16x16x32_bf16 v[232:235], v[48:51], v[160:163], v[232:235]
    buffer_load_dwordx4 v[48:51], v246, s[16:19], s44 offen offset:2048 sc1
    v_mfma_f32_16x16x32_bf16 v[176:179], v[52:55], v[148:151], v[176:179]
    v_mfma_f32_16x16x32_bf16 v[196:199], v[52:55], v[152:155], v[196:199]
    buffer_load_dwordx4 v[144:147], v244, s[16:19], s45 offen offset:768 sc1
    v_mfma_f32_16x16x32_bf16 v[216:219], v[52:55], v[156:159], v[216:219]
    v_mfma_f32_16x16x32_bf16 v[236:239], v[52:55], v[160:163], v[236:239]
    buffer_load_dwordx4 v[52:55], v246, s[16:19], s44 offen offset:3072 sc1
    v_mfma_f32_16x16x32_bf16 v[180:183], v[56:59], v[148:151], v[180:183]
    v_mfma_f32_16x16x32_bf16 v[200:203], v[56:59], v[152:155], v[200:203]
    v_mfma_f32_16x16x32_bf16 v[220:223], v[56:59], v[156:159], v[220:223]
    v_mfma_f32_16x16x32_bf16 v[240:243], v[56:59], v[160:163], v[240:243]
    s_add_u32 s44, s44, 4096
    buffer_load_dwordx4 v[56:59], v246, s[16:19], s44 offen sc1
    s_waitcnt vmcnt(20)
    v_mfma_f32_16x16x32_bf16 v[164:167], v[60:63], v[100:103], v[164:167]
    v_mfma_f32_16x16x32_bf16 v[184:187], v[60:63], v[104:107], v[184:187]
    s_add_u32 s48, s89, 3
    s_mul_i32 s48, s48, 8192
    s_add_u32 s45, s48, s87
    buffer_load_dwordx4 v[148:151], v244, s[16:19], s45 offen offset:0 sc1
    v_mfma_f32_16x16x32_bf16 v[204:207], v[60:63], v[108:111], v[204:207]
    v_mfma_f32_16x16x32_bf16 v[224:227], v[60:63], v[112:115], v[224:227]
    s_add_u32 s48, s89, 5
    s_mul_i32 s48, s48, 40960
    s_add_u32 s44, s48, s86
    s_cmp_lt_u32 s34, 2
    s_cselect_b32 s44, s44, 0x80000000
    buffer_load_dwordx4 v[60:63], v246, s[16:19], s44 offen offset:0 sc1
    v_mfma_f32_16x16x32_bf16 v[168:171], v[64:67], v[100:103], v[168:171]
    v_mfma_f32_16x16x32_bf16 v[188:191], v[64:67], v[104:107], v[188:191]
    buffer_load_dwordx4 v[152:155], v244, s[16:19], s45 offen offset:256 sc1
    v_mfma_f32_16x16x32_bf16 v[208:211], v[64:67], v[108:111], v[208:211]
    v_mfma_f32_16x16x32_bf16 v[228:231], v[64:67], v[112:115], v[228:231]
    buffer_load_dwordx4 v[64:67], v246, s[16:19], s44 offen offset:1024 sc1
    v_mfma_f32_16x16x32_bf16 v[172:175], v[68:71], v[100:103], v[172:175]
    v_mfma_f32_16x16x32_bf16 v[192:195], v[68:71], v[104:107], v[192:195]
    buffer_load_dwordx4 v[156:159], v244, s[16:19], s45 offen offset:512 sc1
    v_mfma_f32_16x16x32_bf16 v[212:215], v[68:71], v[108:111], v[212:215]
    v_mfma_f32_16x16x32_bf16 v[232:235], v[68:71], v[112:115], v[232:235]
    buffer_load_dwordx4 v[68:71], v246, s[16:19], s44 offen offset:2048 sc1
    v_mfma_f32_16x16x32_bf16 v[176:179], v[72:75], v[100:103], v[176:179]
    v_mfma_f32_16x16x32_bf16 v[196:199], v[72:75], v[104:107], v[196:199]
    buffer_load_dwordx4 v[160:163], v244, s[16:19], s45 offen offset:768 sc1
    v_mfma_f32_16x16x32_bf16 v[216:219], v[72:75], v[108:111], v[216:219]
    v_mfma_f32_16x16x32_bf16 v[236:239], v[72:75], v[112:115], v[236:239]
    buffer_load_dwordx4 v[72:75], v246, s[16:19], s44 offen offset:3072 sc1
    v_mfma_f32_16x16x32_bf16 v[180:183], v[76:79], v[100:103], v[180:183]
    v_mfma_f32_16x16x32_bf16 v[200:203], v[76:79], v[104:107], v[200:203]
    v_mfma_f32_16x16x32_bf16 v[220:223], v[76:79], v[108:111], v[220:223]
    v_mfma_f32_16x16x32_bf16 v[240:243], v[76:79], v[112:115], v[240:243]
    s_add_u32 s44, s44, 4096
    buffer_load_dwordx4 v[76:79], v246, s[16:19], s44 offen sc1
    s_waitcnt vmcnt(20)
    v_mfma_f32_16x16x32_bf16 v[164:167], v[80:83], v[116:119], v[164:167]
    v_mfma_f32_16x16x32_bf16 v[184:187], v[80:83], v[120:123], v[184:187]
    s_add_u32 s48, s89, 4
    s_mul_i32 s48, s48, 8192
    s_add_u32 s45, s48, s87
    buffer_load_dwordx4 v[100:103], v244, s[16:19], s45 offen offset:0 sc1
    v_mfma_f32_16x16x32_bf16 v[204:207], v[80:83], v[124:127], v[204:207]
    v_mfma_f32_16x16x32_bf16 v[224:227], v[80:83], v[128:131], v[224:227]
    s_mul_i32 s48, s34, 5
    s_add_u32 s48, s48, 54
    s_mul_i32 s48, s48, 40960
    s_add_u32 s44, s48, s86
    buffer_load_dwordx4 v[80:83], v246, s[16:19], s44 offen offset:0 sc1
    v_mfma_f32_16x16x32_bf16 v[168:171], v[84:87], v[116:119], v[168:171]
    v_mfma_f32_16x16x32_bf16 v[188:191], v[84:87], v[120:123], v[188:191]
    buffer_load_dwordx4 v[104:107], v244, s[16:19], s45 offen offset:256 sc1
    v_mfma_f32_16x16x32_bf16 v[208:211], v[84:87], v[124:127], v[208:211]
    v_mfma_f32_16x16x32_bf16 v[228:231], v[84:87], v[128:131], v[228:231]
    buffer_load_dwordx4 v[84:87], v246, s[16:19], s44 offen offset:1024 sc1
    v_mfma_f32_16x16x32_bf16 v[172:175], v[88:91], v[116:119], v[172:175]
    v_mfma_f32_16x16x32_bf16 v[192:195], v[88:91], v[120:123], v[192:195]
    buffer_load_dwordx4 v[108:111], v244, s[16:19], s45 offen offset:512 sc1
    v_mfma_f32_16x16x32_bf16 v[212:215], v[88:91], v[124:127], v[212:215]
    v_mfma_f32_16x16x32_bf16 v[232:235], v[88:91], v[128:131], v[232:235]
    buffer_load_dwordx4 v[88:91], v246, s[16:19], s44 offen offset:2048 sc1
    v_mfma_f32_16x16x32_bf16 v[176:179], v[92:95], v[116:119], v[176:179]
    v_mfma_f32_16x16x32_bf16 v[196:199], v[92:95], v[120:123], v[196:199]
    buffer_load_dwordx4 v[112:115], v244, s[16:19], s45 offen offset:768 sc1
    v_mfma_f32_16x16x32_bf16 v[216:219], v[92:95], v[124:127], v[216:219]
    v_mfma_f32_16x16x32_bf16 v[236:239], v[92:95], v[128:131], v[236:239]
    buffer_load_dwordx4 v[92:95], v246, s[16:19], s44 offen offset:3072 sc1
    v_mfma_f32_16x16x32_bf16 v[180:183], v[96:99], v[116:119], v[180:183]
    v_mfma_f32_16x16x32_bf16 v[200:203], v[96:99], v[120:123], v[200:203]
    v_mfma_f32_16x16x32_bf16 v[220:223], v[96:99], v[124:127], v[220:223]
    v_mfma_f32_16x16x32_bf16 v[240:243], v[96:99], v[128:131], v[240:243]
    s_add_u32 s44, s44, 4096
    buffer_load_dwordx4 v[96:99], v246, s[16:19], s44 offen sc1
    s_waitcnt vmcnt(20)
    v_mfma_f32_16x16x32_bf16 v[164:167], v[0:3], v[132:135], v[164:167]
    v_mfma_f32_16x16x32_bf16 v[184:187], v[0:3], v[136:139], v[184:187]
    s_add_u32 s48, s89, 5
    s_mul_i32 s48, s48, 8192
    s_add_u32 s45, s48, s87
    s_cmp_lt_u32 s34, 2
    s_cselect_b32 s45, s45, 0x80000000
    buffer_load_dwordx4 v[116:119], v244, s[16:19], s45 offen offset:0 sc1
    v_mfma_f32_16x16x32_bf16 v[204:207], v[0:3], v[140:143], v[204:207]
    v_mfma_f32_16x16x32_bf16 v[224:227], v[0:3], v[144:147], v[224:227]
    s_mul_i32 s48, s34, 5
    s_add_u32 s48, s48, 55
    s_mul_i32 s48, s48, 40960
    s_add_u32 s44, s48, s86
    buffer_load_dwordx4 v[0:3], v246, s[16:19], s44 offen offset:0 sc1
    v_mfma_f32_16x16x32_bf16 v[168:171], v[4:7], v[132:135], v[168:171]
    v_mfma_f32_16x16x32_bf16 v[188:191], v[4:7], v[136:139], v[188:191]
    buffer_load_dwordx4 v[120:123], v244, s[16:19], s45 offen offset:256 sc1
    v_mfma_f32_16x16x32_bf16 v[208:211], v[4:7], v[140:143], v[208:211]
    v_mfma_f32_16x16x32_bf16 v[228:231], v[4:7], v[144:147], v[228:231]
    buffer_load_dwordx4 v[4:7], v246, s[16:19], s44 offen offset:1024 sc1
    v_mfma_f32_16x16x32_bf16 v[172:175], v[8:11], v[132:135], v[172:175]
    v_mfma_f32_16x16x32_bf16 v[192:195], v[8:11], v[136:139], v[192:195]
    buffer_load_dwordx4 v[124:127], v244, s[16:19], s45 offen offset:512 sc1
    v_mfma_f32_16x16x32_bf16 v[212:215], v[8:11], v[140:143], v[212:215]
    v_mfma_f32_16x16x32_bf16 v[232:235], v[8:11], v[144:147], v[232:235]
    buffer_load_dwordx4 v[8:11], v246, s[16:19], s44 offen offset:2048 sc1
    v_mfma_f32_16x16x32_bf16 v[176:179], v[12:15], v[132:135], v[176:179]
    v_mfma_f32_16x16x32_bf16 v[196:199], v[12:15], v[136:139], v[196:199]
    buffer_load_dwordx4 v[128:131], v244, s[16:19], s45 offen offset:768 sc1
    v_mfma_f32_16x16x32_bf16 v[216:219], v[12:15], v[140:143], v[216:219]
    v_mfma_f32_16x16x32_bf16 v[236:239], v[12:15], v[144:147], v[236:239]
    buffer_load_dwordx4 v[12:15], v246, s[16:19], s44 offen offset:3072 sc1
    v_mfma_f32_16x16x32_bf16 v[180:183], v[16:19], v[132:135], v[180:183]
    v_mfma_f32_16x16x32_bf16 v[200:203], v[16:19], v[136:139], v[200:203]
    v_mfma_f32_16x16x32_bf16 v[220:223], v[16:19], v[140:143], v[220:223]
    v_mfma_f32_16x16x32_bf16 v[240:243], v[16:19], v[144:147], v[240:243]
    s_add_u32 s44, s44, 4096
    buffer_load_dwordx4 v[16:19], v246, s[16:19], s44 offen sc1
    s_waitcnt vmcnt(20)
    v_mfma_f32_16x16x32_bf16 v[164:167], v[20:23], v[148:151], v[164:167]
    v_mfma_f32_16x16x32_bf16 v[184:187], v[20:23], v[152:155], v[184:187]
    v_mfma_f32_16x16x32_bf16 v[204:207], v[20:23], v[156:159], v[204:207]
    v_mfma_f32_16x16x32_bf16 v[224:227], v[20:23], v[160:163], v[224:227]
    s_mul_i32 s48, s34, 5
    s_add_u32 s48, s48, 56
    s_mul_i32 s48, s48, 40960
    s_add_u32 s44, s48, s86
    buffer_load_dwordx4 v[20:23], v246, s[16:19], s44 offen offset:0 sc1
    v_mfma_f32_16x16x32_bf16 v[168:171], v[24:27], v[148:151], v[168:171]
    v_mfma_f32_16x16x32_bf16 v[188:191], v[24:27], v[152:155], v[188:191]
    v_mfma_f32_16x16x32_bf16 v[208:211], v[24:27], v[156:159], v[208:211]
    v_mfma_f32_16x16x32_bf16 v[228:231], v[24:27], v[160:163], v[228:231]
    buffer_load_dwordx4 v[24:27], v246, s[16:19], s44 offen offset:1024 sc1
    v_mfma_f32_16x16x32_bf16 v[172:175], v[28:31], v[148:151], v[172:175]
    v_mfma_f32_16x16x32_bf16 v[192:195], v[28:31], v[152:155], v[192:195]
    v_mfma_f32_16x16x32_bf16 v[212:215], v[28:31], v[156:159], v[212:215]
    v_mfma_f32_16x16x32_bf16 v[232:235], v[28:31], v[160:163], v[232:235]
    buffer_load_dwordx4 v[28:31], v246, s[16:19], s44 offen offset:2048 sc1
    v_mfma_f32_16x16x32_bf16 v[176:179], v[32:35], v[148:151], v[176:179]
    v_mfma_f32_16x16x32_bf16 v[196:199], v[32:35], v[152:155], v[196:199]
    v_mfma_f32_16x16x32_bf16 v[216:219], v[32:35], v[156:159], v[216:219]
    v_mfma_f32_16x16x32_bf16 v[236:239], v[32:35], v[160:163], v[236:239]
    buffer_load_dwordx4 v[32:35], v246, s[16:19], s44 offen offset:3072 sc1
    v_mfma_f32_16x16x32_bf16 v[180:183], v[36:39], v[148:151], v[180:183]
    v_mfma_f32_16x16x32_bf16 v[200:203], v[36:39], v[152:155], v[200:203]
    v_mfma_f32_16x16x32_bf16 v[220:223], v[36:39], v[156:159], v[220:223]
    v_mfma_f32_16x16x32_bf16 v[240:243], v[36:39], v[160:163], v[240:243]
    s_add_u32 s44, s44, 4096
    buffer_load_dwordx4 v[36:39], v246, s[16:19], s44 offen sc1
    s_waitcnt vmcnt(16)
    v_mfma_f32_16x16x32_bf16 v[164:167], v[40:43], v[100:103], v[164:167]
    v_mfma_f32_16x16x32_bf16 v[184:187], v[40:43], v[104:107], v[184:187]
    v_mfma_f32_16x16x32_bf16 v[204:207], v[40:43], v[108:111], v[204:207]
    v_mfma_f32_16x16x32_bf16 v[224:227], v[40:43], v[112:115], v[224:227]
    s_mul_i32 s48, s34, 5
    s_add_u32 s48, s48, 57
    s_mul_i32 s48, s48, 40960
    s_add_u32 s44, s48, s86
    buffer_load_dwordx4 v[40:43], v246, s[16:19], s44 offen offset:0 sc1
    v_mfma_f32_16x16x32_bf16 v[168:171], v[44:47], v[100:103], v[168:171]
    v_mfma_f32_16x16x32_bf16 v[188:191], v[44:47], v[104:107], v[188:191]
    v_mfma_f32_16x16x32_bf16 v[208:211], v[44:47], v[108:111], v[208:211]
    v_mfma_f32_16x16x32_bf16 v[228:231], v[44:47], v[112:115], v[228:231]
    buffer_load_dwordx4 v[44:47], v246, s[16:19], s44 offen offset:1024 sc1
    v_mfma_f32_16x16x32_bf16 v[172:175], v[48:51], v[100:103], v[172:175]
    v_mfma_f32_16x16x32_bf16 v[192:195], v[48:51], v[104:107], v[192:195]
    v_mfma_f32_16x16x32_bf16 v[212:215], v[48:51], v[108:111], v[212:215]
    v_mfma_f32_16x16x32_bf16 v[232:235], v[48:51], v[112:115], v[232:235]
    buffer_load_dwordx4 v[48:51], v246, s[16:19], s44 offen offset:2048 sc1
    v_mfma_f32_16x16x32_bf16 v[176:179], v[52:55], v[100:103], v[176:179]
    v_mfma_f32_16x16x32_bf16 v[196:199], v[52:55], v[104:107], v[196:199]
    v_mfma_f32_16x16x32_bf16 v[216:219], v[52:55], v[108:111], v[216:219]
    v_mfma_f32_16x16x32_bf16 v[236:239], v[52:55], v[112:115], v[236:239]
    buffer_load_dwordx4 v[52:55], v246, s[16:19], s44 offen offset:3072 sc1
    v_mfma_f32_16x16x32_bf16 v[180:183], v[56:59], v[100:103], v[180:183]
    v_mfma_f32_16x16x32_bf16 v[200:203], v[56:59], v[104:107], v[200:203]
    v_mfma_f32_16x16x32_bf16 v[220:223], v[56:59], v[108:111], v[220:223]
    v_mfma_f32_16x16x32_bf16 v[240:243], v[56:59], v[112:115], v[240:243]
    s_add_u32 s44, s44, 4096
    buffer_load_dwordx4 v[56:59], v246, s[16:19], s44 offen sc1
    s_waitcnt vmcnt(12)
    v_mfma_f32_16x16x32_bf16 v[164:167], v[60:63], v[116:119], v[164:167]
    v_mfma_f32_16x16x32_bf16 v[184:187], v[60:63], v[120:123], v[184:187]
    v_mfma_f32_16x16x32_bf16 v[204:207], v[60:63], v[124:127], v[204:207]
    v_mfma_f32_16x16x32_bf16 v[224:227], v[60:63], v[128:131], v[224:227]
    s_mul_i32 s48, s34, 5
    s_add_u32 s48, s48, 58
    s_mul_i32 s48, s48, 40960
    s_add_u32 s44, s48, s86
    buffer_load_dwordx4 v[60:63], v246, s[16:19], s44 offen offset:0 sc1
    v_mfma_f32_16x16x32_bf16 v[168:171], v[64:67], v[116:119], v[168:171]
    v_mfma_f32_16x16x32_bf16 v[188:191], v[64:67], v[120:123], v[188:191]
    v_mfma_f32_16x16x32_bf16 v[208:211], v[64:67], v[124:127], v[208:211]
    v_mfma_f32_16x16x32_bf16 v[228:231], v[64:67], v[128:131], v[228:231]
    buffer_load_dwordx4 v[64:67], v246, s[16:19], s44 offen offset:1024 sc1
    v_mfma_f32_16x16x32_bf16 v[172:175], v[68:71], v[116:119], v[172:175]
    v_mfma_f32_16x16x32_bf16 v[192:195], v[68:71], v[120:123], v[192:195]
    v_mfma_f32_16x16x32_bf16 v[212:215], v[68:71], v[124:127], v[212:215]
    v_mfma_f32_16x16x32_bf16 v[232:235], v[68:71], v[128:131], v[232:235]
    buffer_load_dwordx4 v[68:71], v246, s[16:19], s44 offen offset:2048 sc1
    v_mfma_f32_16x16x32_bf16 v[176:179], v[72:75], v[116:119], v[176:179]
    v_mfma_f32_16x16x32_bf16 v[196:199], v[72:75], v[120:123], v[196:199]
    v_mfma_f32_16x16x32_bf16 v[216:219], v[72:75], v[124:127], v[216:219]
    v_mfma_f32_16x16x32_bf16 v[236:239], v[72:75], v[128:131], v[236:239]
    buffer_load_dwordx4 v[72:75], v246, s[16:19], s44 offen offset:3072 sc1
    v_mfma_f32_16x16x32_bf16 v[180:183], v[76:79], v[116:119], v[180:183]
    v_mfma_f32_16x16x32_bf16 v[200:203], v[76:79], v[120:123], v[200:203]
    v_mfma_f32_16x16x32_bf16 v[220:223], v[76:79], v[124:127], v[220:223]
    v_mfma_f32_16x16x32_bf16 v[240:243], v[76:79], v[128:131], v[240:243]
    s_add_u32 s44, s44, 4096
    buffer_load_dwordx4 v[76:79], v246, s[16:19], s44 offen sc1
    v_lshrrev_b32 v250, 1, v249
    v_and_b32 v250, 3, v250
    s_lshl_b32 s48, s84, 2
    s_add_u32 s48, s48, s34
    s_lshl_b32 s48, s48, 9
    s_lshl_b32 s49, s85, 3
    s_add_u32 s48, s48, s49
    s_add_u32 s48, s48, 0x21000
    v_lshl_add_u32 v251, v250, 7, s48
    v_and_b32 v250, 1, v249
    v_lshl_add_u32 v247, v250, 2, v251
    buffer_load_dword v248, v247, s[16:19], 0 offen sc1
    v_mbcnt_lo_u32_b32 v100, -1, 0
    v_mbcnt_hi_u32_b32 v100, -1, v100
    s_lshl_b32 s46, s82, 6
    s_lshl_b32 s47, s33, 3
    s_add_u32 s46, s46, s47
    s_mul_i32 s46, s46, 1280
    s_mul_i32 s48, s83, 160
    s_add_u32 s46, s46, s48
    s_mul_i32 s47, s47, 336
    v_add_u32 v101, 0, v100
    v_mul_u32_u24 v102, 0xccd, v101
    v_lshrrev_b32 v102, 16, v102
    v_mul_u32_u24 v103, 20, v102
    v_sub_u32 v103, v101, v103
    v_mul_u32_u24 v246, 336, v102
    v_lshl_add_u32 v246, v103, 4, v246
    v_add_u32 v246, s47, v246
    v_mul_u32_u24 v251, 0x500, v102
    v_lshl_add_u32 v251, v103, 3, v251
    v_add_u32 v251, s46, v251
    v_add_u32 v101, 64, v100
    v_mul_u32_u24 v102, 0xccd, v101
    v_lshrrev_b32 v102, 16, v102
    v_mul_u32_u24 v103, 20, v102
    v_sub_u32 v103, v101, v103
    v_mul_u32_u24 v245, 336, v102
    v_lshl_add_u32 v245, v103, 4, v245
    v_add_u32 v245, s47, v245
    v_mul_u32_u24 v252, 0x500, v102
    v_lshl_add_u32 v252, v103, 3, v252
    v_add_u32 v252, s46, v252
    v_add_u32 v101, 128, v100
    v_mul_u32_u24 v102, 0xccd, v101
    v_lshrrev_b32 v102, 16, v102
    v_mul_u32_u24 v103, 20, v102
    v_sub_u32 v103, v101, v103
    v_mul_u32_u24 v250, 336, v102
    v_lshl_add_u32 v250, v103, 4, v250
    v_add_u32 v250, s47, v250
    v_mul_u32_u24 v253, 0x500, v102
    v_lshl_add_u32 v253, v103, 3, v253
    v_add_u32 v253, s46, v253
    v_cmp_gt_u32 vcc, 32, v100
    v_mov_b32 v102, 0x80000000
    s_nop 0
    v_cndmask_b32 v253, v102, v253, vcc
    v_cndmask_b32 v250, 0, v250, vcc
    s_waitcnt vmcnt(0)
    v_cmp_ne_u32 vcc, s32, v248
    s_cbranch_vccz L_early_40
    s_mov_b32 s65, 0x10000
L_poll_41:
    buffer_load_dword v248, v247, s[16:19], 0 offen sc1
    s_waitcnt vmcnt(0)
    v_cmp_ne_u32 vcc, s32, v248
    s_cbranch_vccz L_polled_42
    s_sleep 1
    s_sub_u32 s65, s65, 1
    s_cbranch_scc0 L_poll_41
    v_mov_b32 v248, 6
    v_mov_b32 v255, 0
    global_store_dword v255, v248, s[80:81]
L_polled_42:
L_early_40:
    s_mul_i32 s48, s34, 5
    s_add_u32 s48, s48, 54
    s_mul_i32 s48, s48, 8192
    s_add_u32 s45, s48, s87
    buffer_load_dwordx4 v[132:135], v244, s[16:19], s45 offen offset:0 sc1
    buffer_load_dwordx4 v[136:139], v244, s[16:19], s45 offen offset:256 sc1
    buffer_load_dwordx4 v[140:143], v244, s[16:19], s45 offen offset:512 sc1
    buffer_load_dwordx4 v[144:147], v244, s[16:19], s45 offen offset:768 sc1
    s_mul_i32 s48, s34, 5
    s_add_u32 s48, s48, 55
    s_mul_i32 s48, s48, 8192
    s_add_u32 s45, s48, s87
    buffer_load_dwordx4 v[148:151], v244, s[16:19], s45 offen offset:0 sc1
    buffer_load_dwordx4 v[152:155], v244, s[16:19], s45 offen offset:256 sc1
    buffer_load_dwordx4 v[156:159], v244, s[16:19], s45 offen offset:512 sc1
    buffer_load_dwordx4 v[160:163], v244, s[16:19], s45 offen offset:768 sc1
    s_mul_i32 s48, s34, 5
    s_add_u32 s48, s48, 56
    s_mul_i32 s48, s48, 8192
    s_add_u32 s45, s48, s87
    buffer_load_dwordx4 v[100:103], v244, s[16:19], s45 offen offset:0 sc1
    buffer_load_dwordx4 v[104:107], v244, s[16:19], s45 offen offset:256 sc1
    buffer_load_dwordx4 v[108:111], v244, s[16:19], s45 offen offset:512 sc1
    buffer_load_dwordx4 v[112:115], v244, s[16:19], s45 offen offset:768 sc1
    s_mul_i32 s48, s34, 5
    s_add_u32 s48, s48, 57
    s_mul_i32 s48, s48, 8192
    s_add_u32 s45, s48, s87
    buffer_load_dwordx4 v[116:119], v244, s[16:19], s45 offen offset:0 sc1
    buffer_load_dwordx4 v[120:123], v244, s[16:19], s45 offen offset:256 sc1
    buffer_load_dwordx4 v[124:127], v244, s[16:19], s45 offen offset:512 sc1
    buffer_load_dwordx4 v[128:131], v244, s[16:19], s45 offen offset:768 sc1
    v_and_b32 v248, 15, v249
    v_mul_u32_u24 v248, 336, v248
    v_lshrrev_b32 v247, 4, v249
    v_lshl_add_u32 v248, v247, 4, v248
    s_mul_i32 s46, s34, 21504
    v_add_u32 v248, s46, v248
    s_barrier
    s_waitcnt vmcnt(12)
    v_mfma_f32_16x16x32_bf16 v[164:167], v[80:83], v[132:135], v[164:167]
    v_mfma_f32_16x16x32_bf16 v[184:187], v[80:83], v[136:139], v[184:187]
    v_mfma_f32_16x16x32_bf16 v[204:207], v[80:83], v[140:143], v[204:207]
    v_mfma_f32_16x16x32_bf16 v[224:227], v[80:83], v[144:147], v[224:227]
    v_mfma_f32_16x16x32_bf16 v[168:171], v[84:87], v[132:135], v[168:171]
    v_mfma_f32_16x16x32_bf16 v[188:191], v[84:87], v[136:139], v[188:191]
    v_mfma_f32_16x16x32_bf16 v[208:211], v[84:87], v[140:143], v[208:211]
    v_mfma_f32_16x16x32_bf16 v[228:231], v[84:87], v[144:147], v[228:231]
    v_mfma_f32_16x16x32_bf16 v[172:175], v[88:91], v[132:135], v[172:175]
    v_mfma_f32_16x16x32_bf16 v[192:195], v[88:91], v[136:139], v[192:195]
    v_mfma_f32_16x16x32_bf16 v[212:215], v[88:91], v[140:143], v[212:215]
    v_mfma_f32_16x16x32_bf16 v[232:235], v[88:91], v[144:147], v[232:235]
    v_mfma_f32_16x16x32_bf16 v[176:179], v[92:95], v[132:135], v[176:179]
    v_mfma_f32_16x16x32_bf16 v[196:199], v[92:95], v[136:139], v[196:199]
    v_mfma_f32_16x16x32_bf16 v[216:219], v[92:95], v[140:143], v[216:219]
    v_mfma_f32_16x16x32_bf16 v[236:239], v[92:95], v[144:147], v[236:239]
    v_mfma_f32_16x16x32_bf16 v[180:183], v[96:99], v[132:135], v[180:183]
    v_mfma_f32_16x16x32_bf16 v[200:203], v[96:99], v[136:139], v[200:203]
    v_mfma_f32_16x16x32_bf16 v[220:223], v[96:99], v[140:143], v[220:223]
    v_mfma_f32_16x16x32_bf16 v[240:243], v[96:99], v[144:147], v[240:243]
    buffer_load_dwordx2 v[80:81], v251, s[4:7], 0 offen
    buffer_load_dwordx2 v[82:83], v252, s[4:7], 0 offen
    buffer_load_dwordx2 v[84:85], v253, s[4:7], 0 offen
    s_waitcnt vmcnt(11)
    v_mfma_f32_16x16x32_bf16 v[164:167], v[0:3], v[148:151], v[164:167]
    v_mfma_f32_16x16x32_bf16 v[184:187], v[0:3], v[152:155], v[184:187]
    s_mul_i32 s48, s34, 5
    s_add_u32 s48, s48, 58
    s_mul_i32 s48, s48, 8192
    s_add_u32 s45, s48, s87
    buffer_load_dwordx4 v[132:135], v244, s[16:19], s45 offen offset:0 sc1
    v_mfma_f32_16x16x32_bf16 v[204:207], v[0:3], v[156:159], v[204:207]
    v_mfma_f32_16x16x32_bf16 v[224:227], v[0:3], v[160:163], v[224:227]
    v_mfma_f32_16x16x32_bf16 v[168:171], v[4:7], v[148:151], v[168:171]
    v_mfma_f32_16x16x32_bf16 v[188:191], v[4:7], v[152:155], v[188:191]
    buffer_load_dwordx4 v[136:139], v244, s[16:19], s45 offen offset:256 sc1
    v_mfma_f32_16x16x32_bf16 v[208:211], v[4:7], v[156:159], v[208:211]
    v_mfma_f32_16x16x32_bf16 v[228:231], v[4:7], v[160:163], v[228:231]
    v_mfma_f32_16x16x32_bf16 v[172:175], v[8:11], v[148:151], v[172:175]
    v_mfma_f32_16x16x32_bf16 v[192:195], v[8:11], v[152:155], v[192:195]
    buffer_load_dwordx4 v[140:143], v244, s[16:19], s45 offen offset:512 sc1
    v_mfma_f32_16x16x32_bf16 v[212:215], v[8:11], v[156:159], v[212:215]
    v_mfma_f32_16x16x32_bf16 v[232:235], v[8:11], v[160:163], v[232:235]
    v_mfma_f32_16x16x32_bf16 v[176:179], v[12:15], v[148:151], v[176:179]
    v_mfma_f32_16x16x32_bf16 v[196:199], v[12:15], v[152:155], v[196:199]
    buffer_load_dwordx4 v[144:147], v244, s[16:19], s45 offen offset:768 sc1
    v_mfma_f32_16x16x32_bf16 v[216:219], v[12:15], v[156:159], v[216:219]
    v_mfma_f32_16x16x32_bf16 v[236:239], v[12:15], v[160:163], v[236:239]
    v_mfma_f32_16x16x32_bf16 v[180:183], v[16:19], v[148:151], v[180:183]
    v_mfma_f32_16x16x32_bf16 v[200:203], v[16:19], v[152:155], v[200:203]
    v_mfma_f32_16x16x32_bf16 v[220:223], v[16:19], v[156:159], v[220:223]
    v_mfma_f32_16x16x32_bf16 v[240:243], v[16:19], v[160:163], v[240:243]
    s_waitcnt vmcnt(11)
    v_mfma_f32_16x16x32_bf16 v[164:167], v[20:23], v[100:103], v[164:167]
    v_mfma_f32_16x16x32_bf16 v[184:187], v[20:23], v[104:107], v[184:187]
    v_mfma_f32_16x16x32_bf16 v[204:207], v[20:23], v[108:111], v[204:207]
    v_mfma_f32_16x16x32_bf16 v[224:227], v[20:23], v[112:115], v[224:227]
    v_mfma_f32_16x16x32_bf16 v[168:171], v[24:27], v[100:103], v[168:171]
    v_mfma_f32_16x16x32_bf16 v[188:191], v[24:27], v[104:107], v[188:191]
    v_mfma_f32_16x16x32_bf16 v[208:211], v[24:27], v[108:111], v[208:211]
    v_mfma_f32_16x16x32_bf16 v[228:231], v[24:27], v[112:115], v[228:231]
    v_mfma_f32_16x16x32_bf16 v[172:175], v[28:31], v[100:103], v[172:175]
    v_mfma_f32_16x16x32_bf16 v[192:195], v[28:31], v[104:107], v[192:195]
    v_mfma_f32_16x16x32_bf16 v[212:215], v[28:31], v[108:111], v[212:215]
    v_mfma_f32_16x16x32_bf16 v[232:235], v[28:31], v[112:115], v[232:235]
    v_mfma_f32_16x16x32_bf16 v[176:179], v[32:35], v[100:103], v[176:179]
    v_mfma_f32_16x16x32_bf16 v[196:199], v[32:35], v[104:107], v[196:199]
    v_mfma_f32_16x16x32_bf16 v[216:219], v[32:35], v[108:111], v[216:219]
    v_mfma_f32_16x16x32_bf16 v[236:239], v[32:35], v[112:115], v[236:239]
    v_mfma_f32_16x16x32_bf16 v[180:183], v[36:39], v[100:103], v[180:183]
    v_mfma_f32_16x16x32_bf16 v[200:203], v[36:39], v[104:107], v[200:203]
    v_mfma_f32_16x16x32_bf16 v[220:223], v[36:39], v[108:111], v[220:223]
    v_mfma_f32_16x16x32_bf16 v[240:243], v[36:39], v[112:115], v[240:243]
    s_waitcnt vmcnt(7)
    v_mfma_f32_16x16x32_bf16 v[164:167], v[40:43], v[116:119], v[164:167]
    v_mfma_f32_16x16x32_bf16 v[184:187], v[40:43], v[120:123], v[184:187]
    v_mfma_f32_16x16x32_bf16 v[204:207], v[40:43], v[124:127], v[204:207]
    v_mfma_f32_16x16x32_bf16 v[224:227], v[40:43], v[128:131], v[224:227]
    v_mfma_f32_16x16x32_bf16 v[168:171], v[44:47], v[116:119], v[168:171]
    v_mfma_f32_16x16x32_bf16 v[188:191], v[44:47], v[120:123], v[188:191]
    v_mfma_f32_16x16x32_bf16 v[208:211], v[44:47], v[124:127], v[208:211]
    v_mfma_f32_16x16x32_bf16 v[228:231], v[44:47], v[128:131], v[228:231]
    v_mfma_f32_16x16x32_bf16 v[172:175], v[48:51], v[116:119], v[172:175]
    v_mfma_f32_16x16x32_bf16 v[192:195], v[48:51], v[120:123], v[192:195]
    v_mfma_f32_16x16x32_bf16 v[212:215], v[48:51], v[124:127], v[212:215]
    v_mfma_f32_16x16x32_bf16 v[232:235], v[48:51], v[128:131], v[232:235]
    v_mfma_f32_16x16x32_bf16 v[176:179], v[52:55], v[116:119], v[176:179]
    v_mfma_f32_16x16x32_bf16 v[196:199], v[52:55], v[120:123], v[196:199]
    v_mfma_f32_16x16x32_bf16 v[216:219], v[52:55], v[124:127], v[216:219]
    v_mfma_f32_16x16x32_bf16 v[236:239], v[52:55], v[128:131], v[236:239]
    v_mfma_f32_16x16x32_bf16 v[180:183], v[56:59], v[116:119], v[180:183]
    v_mfma_f32_16x16x32_bf16 v[200:203], v[56:59], v[120:123], v[200:203]
    v_mfma_f32_16x16x32_bf16 v[220:223], v[56:59], v[124:127], v[220:223]
    v_mfma_f32_16x16x32_bf16 v[240:243], v[56:59], v[128:131], v[240:243]
    s_waitcnt vmcnt(0)
    v_mfma_f32_16x16x32_bf16 v[164:167], v[60:63], v[132:135], v[164:167]
    v_mfma_f32_16x16x32_bf16 v[184:187], v[60:63], v[136:139], v[184:187]
    v_mfma_f32_16x16x32_bf16 v[204:207], v[60:63], v[140:143], v[204:207]
    v_mfma_f32_16x16x32_bf16 v[224:227], v[60:63], v[144:147], v[224:227]
    v_mfma_f32_16x16x32_bf16 v[168:171], v[64:67], v[132:135], v[168:171]
    v_mfma_f32_16x16x32_bf16 v[188:191], v[64:67], v[136:139], v[188:191]
    v_mfma_f32_16x16x32_bf16 v[208:211], v[64:67], v[140:143], v[208:211]
    v_mfma_f32_16x16x32_bf16 v[228:231], v[64:67], v[144:147], v[228:231]
    v_mfma_f32_16x16x32_bf16 v[172:175], v[68:71], v[132:135], v[172:175]
    ds_write_b128 v248, v[164:167] offset:0
    v_mfma_f32_16x16x32_bf16 v[192:195], v[68:71], v[136:139], v[192:195]
    ds_write_b128 v248, v[184:187] offset:5376
    v_mfma_f32_16x16x32_bf16 v[212:215], v[68:71], v[140:143], v[212:215]
    ds_write_b128 v248, v[204:207] offset:10752
    v_mfma_f32_16x16x32_bf16 v[232:235], v[68:71], v[144:147], v[232:235]
    ds_write_b128 v248, v[224:227] offset:16128
    v_mfma_f32_16x16x32_bf16 v[176:179], v[72:75], v[132:135], v[176:179]
    ds_write_b128 v248, v[168:171] offset:64
    v_mfma_f32_16x16x32_bf16 v[196:199], v[72:75], v[136:139], v[196:199]
    ds_write_b128 v248, v[188:191] offset:5440
    v_mfma_f32_16x16x32_bf16 v[216:219], v[72:75], v[140:143], v[216:219]
    ds_write_b128 v248, v[208:211] offset:10816
    v_mfma_f32_16x16x32_bf16 v[236:239], v[72:75], v[144:147], v[236:239]
    ds_write_b128 v248, v[228:231] offset:16192
    v_mfma_f32_16x16x32_bf16 v[180:183], v[76:79], v[132:135], v[180:183]
    ds_write_b128 v248, v[172:175] offset:128
    v_mfma_f32_16x16x32_bf16 v[200:203], v[76:79], v[136:139], v[200:203]
    ds_write_b128 v248, v[192:195] offset:5504
    v_mfma_f32_16x16x32_bf16 v[220:223], v[76:79], v[140:143], v[220:223]
    ds_write_b128 v248, v[212:215] offset:10880
    v_mfma_f32_16x16x32_bf16 v[240:243], v[76:79], v[144:147], v[240:243]
    ds_write_b128 v248, v[232:235] offset:16256
    ds_write_b128 v248, v[176:179] offset:192
    ds_write_b128 v248, v[196:199] offset:5568
    ds_write_b128 v248, v[216:219] offset:10944
    ds_write_b128 v248, v[236:239] offset:16320
    ds_write_b128 v248, v[180:183] offset:256
    ds_write_b128 v248, v[200:203] offset:5632
    ds_write_b128 v248, v[220:223] offset:11008
    ds_write_b128 v248, v[240:243] offset:16384
    s_waitcnt lgkmcnt(0)
    s_branch L_final
L_att:
    s_nop 1
    s_setprio 1
    v_mbcnt_lo_u32_b32 v100, -1, 0
    v_mbcnt_hi_u32_b32 v100, -1, v100
    s_lshl_b32 s46, s33, 9
    v_lshrrev_b32 v101, 4, v100
    v_and_b32 v102, 15, v100
    v_lshl_add_u32 v103, v102, 4, s46
    v_min_u32 v105, 2, v101
    v_lshl_add_u32 v104, v105, 11, v103
    v_add_u32 v104, 153600, v104
    ds_read_b128 v[32:35], v104
    ds_read_b128 v[36:39], v104 offset:256
    v_cmp_eq_u32 s[76:77], 3, v101
    v_cmp_gt_u32 vcc, 2, v101
    v_mul_u32_u24 v106, 6144, v105
    v_add_u32 v106, 49152, v106
    v_mov_b32 v107, 147456
    v_cndmask_b32 v106, v106, v107, s[76:77]
    v_add_u32 v228, v106, v103
    ds_read_b128 v[136:139], v228 offset:0
    ds_read_b128 v[140:143], v228 offset:256
    ds_read_b128 v[144:147], v228 offset:512
    ds_read_b128 v[148:151], v228 offset:768
    v_mov_b32 v106, 157696
    v_mov_b32 v107, 159744
    v_cmp_eq_u32 s[78:79], 0, v101
    v_cmp_eq_u32 s[74:75], 1, v101
    v_mov_b32 v108, 79872
    v_cndmask_b32 v106, v106, v107, s[78:79]
    v_cndmask_b32 v106, v106, v108, s[74:75]
    v_add_u32 v104, v106, v103
    ds_read_b128 v[40:43], v104
    ds_read_b128 v[44:47], v104 offset:256
    v_mov_b32 v107, 18432
    v_cndmask_b32 v107, 0, v107, vcc
    v_add_u32 v229, v228, v107
    v_mov_b32 v106, 0x80000000
    v_cndmask_b32 v234, v106, v252, vcc
    v_cmp_eq_u32 s[74:75], 2, v101
    v_lshrrev_b32 v106, 2, v100
    v_lshl_add_u32 v106, v106, 4, s46
    v_and_b32 v107, 3, v100
    v_lshrrev_b32 v108, 1, v107
    v_mul_u32_u24 v108, 6272, v108
    v_and_b32 v109, 1, v107
    v_lshl_add_u32 v108, v109, 3, v108
    v_add_u32 v108, v108, v106
    v_add_u32 v230, 98304, v108
    v_add_u32 v231, 117120, v108
    v_mov_b32 v108, 147464
    v_add_u32 v109, 110848, v106
    v_cmp_eq_u32 vcc, 0, v107
    s_nop 1
    v_cndmask_b32 v232, v108, v109, vcc
    v_add_u32 v109, 8, v109
    v_cmp_eq_u32 vcc, 1, v107
    s_nop 1
    v_cndmask_b32 v233, v108, v109, vcc
    ds_read_b64_tr_b16 v[152:153], v230 offset:0
    ds_read_b64_tr_b16 v[154:155], v230 offset:256
    ds_read_b64_tr_b16 v[156:157], v232 offset:0
    ds_read_b64_tr_b16 v[158:159], v232 offset:256
    v_lshlrev_b32 v106, 2, v101
    v_mov_b32 v107, 0xf149f2ca
    v_add_u32 v108, 0, v106
    v_cmp_gt_u32 vcc, v108, v102
    s_nop 1
    v_cndmask_b32 v216, 0, v107, vcc
    v_sub_f32 v220, v107, v216
    v_add_u32 v108, 1, v106
    v_cmp_gt_u32 vcc, v108, v102
    s_nop 1
    v_cndmask_b32 v217, 0, v107, vcc
    v_sub_f32 v221, v107, v217
    v_add_u32 v108, 2, v106
    v_cmp_gt_u32 vcc, v108, v102
    s_nop 1
    v_cndmask_b32 v218, 0, v107, vcc
    v_sub_f32 v222, v107, v218
    v_add_u32 v108, 3, v106
    v_cmp_gt_u32 vcc, v108, v102
    s_nop 1
    v_cndmask_b32 v219, 0, v107, vcc
    v_sub_f32 v223, v107, v219
    s_mul_i32 s47, s36, 296
    s_mul_i32 s48, s38, 5
    s_add_u32 s47, s47, s48
    s_add_u32 s47, s47, 216
    s_lshl_b32 s47, s47, 11
    s_add_u32 s58, s47, 0x7c0000
    s_waitcnt lgkmcnt(4)
    s_or_b64 vcc, s[74:75], s[76:77]
    v_mov_b32 v106, 0x3f80
    v_cndmask_b32 v200, v32, v106, s[76:77]
    v_cndmask_b32 v201, v33, 0, s[76:77]
    v_cndmask_b32 v202, v34, 0, vcc
    v_cndmask_b32 v203, v35, 0, vcc
    v_cndmask_b32 v204, v36, v106, s[76:77]
    v_cndmask_b32 v205, v37, 0, s[76:77]
    v_cndmask_b32 v206, v38, 0, vcc
    v_cndmask_b32 v207, v39, 0, vcc
    v_cndmask_b32 v208, v40, 0, s[74:75]
    v_cndmask_b32 v209, v41, 0, vcc
    v_cndmask_b32 v208, v208, v106, s[76:77]
    v_cndmask_b32 v210, v42, 0, s[76:77]
    v_cndmask_b32 v211, v43, 0, s[76:77]
    v_cndmask_b32 v212, v44, 0, s[74:75]
    v_cndmask_b32 v213, v45, 0, vcc
    v_cndmask_b32 v212, v212, v106, s[76:77]
    v_cndmask_b32 v214, v46, 0, s[76:77]
    v_cndmask_b32 v215, v47, 0, s[76:77]
    v_mfma_f32_16x16x32_bf16 v[0:3], v[136:139], v[200:203], v[220:223]
    v_mfma_f32_16x16x32_bf16 v[4:7], v[140:143], v[200:203], 0
    v_mfma_f32_16x16x32_bf16 v[8:11], v[140:143], v[204:207], v[220:223]
    s_nop 5
    v_exp_f32 v0, v0
    v_exp_f32 v1, v1
    ds_read_b128 v[136:139], v228 offset:1024
    ds_read_b128 v[140:143], v228 offset:1280
    v_mfma_f32_16x16x32_bf16 v[16:19], v[144:147], v[200:203], 0
    v_exp_f32 v2, v2
    v_mfma_f32_16x16x32_bf16 v[20:23], v[148:151], v[200:203], 0
    v_exp_f32 v3, v3
    v_exp_f32 v4, v4
    v_exp_f32 v5, v5
    v_exp_f32 v6, v6
    v_exp_f32 v7, v7
    v_cvt_pk_bf16_f32 v0, v0, v1
    v_cvt_pk_bf16_f32 v1, v2, v3
    v_cvt_pk_bf16_f32 v2, v4, v5
    v_cvt_pk_bf16_f32 v3, v6, v7
    v_exp_f32 v8, v8
    v_exp_f32 v9, v9
    s_waitcnt lgkmcnt(2)
    v_mfma_f32_16x16x32_bf16 v[168:171], v[152:155], v[0:3], 0
    v_exp_f32 v10, v10
    v_mfma_f32_16x16x32_bf16 v[176:179], v[156:159], v[0:3], 0
    v_exp_f32 v11, v11
    v_mfma_f32_16x16x32_bf16 v[24:27], v[144:147], v[204:207], 0
    v_cvt_pk_bf16_f32 v8, v8, v9
    v_mfma_f32_16x16x32_bf16 v[28:31], v[148:151], v[204:207], 0
    v_cvt_pk_bf16_f32 v9, v10, v11
    ds_read_b64_tr_b16 v[160:161], v230 offset:512
    ds_read_b64_tr_b16 v[162:163], v230 offset:768
    ds_read_b64_tr_b16 v[164:165], v232 offset:512
    ds_read_b64_tr_b16 v[166:167], v232 offset:768
    v_exp_f32 v16, v16
    v_exp_f32 v17, v17
    ds_read_b128 v[144:147], v228 offset:1536
    ds_read_b128 v[148:151], v228 offset:1792
    v_mfma_f32_16x16x16_bf16 v[172:175], v[154:155], v[8:9], 0
    v_exp_f32 v18, v18
    v_mfma_f32_16x16x16_bf16 v[180:183], v[158:159], v[8:9], 0
    v_exp_f32 v19, v19
    ds_read_b64_tr_b16 v[152:153], v230 offset:1024
    ds_read_b64_tr_b16 v[154:155], v230 offset:1280
    ds_read_b64_tr_b16 v[156:157], v232 offset:1024
    ds_read_b64_tr_b16 v[158:159], v232 offset:1280
    s_waitcnt lgkmcnt(10)
    v_mfma_f32_16x16x32_bf16 v[0:3], v[136:139], v[200:203], 0
    v_exp_f32 v20, v20
    v_mfma_f32_16x16x32_bf16 v[4:7], v[140:143], v[200:203], 0
    v_exp_f32 v21, v21
    v_exp_f32 v22, v22
    v_exp_f32 v23, v23
    v_cvt_pk_bf16_f32 v16, v16, v17
    v_cvt_pk_bf16_f32 v17, v18, v19
    v_cvt_pk_bf16_f32 v18, v20, v21
    v_cvt_pk_bf16_f32 v19, v22, v23
    v_exp_f32 v24, v24
    v_exp_f32 v25, v25
    s_waitcnt lgkmcnt(6)
    v_mfma_f32_16x16x32_bf16 v[168:171], v[160:163], v[16:19], v[168:171]
    v_exp_f32 v26, v26
    v_mfma_f32_16x16x32_bf16 v[176:179], v[164:167], v[16:19], v[176:179]
    v_exp_f32 v27, v27
    v_mfma_f32_16x16x32_bf16 v[8:11], v[136:139], v[204:207], 0
    v_exp_f32 v28, v28
    v_mfma_f32_16x16x32_bf16 v[12:15], v[140:143], v[204:207], 0
    v_exp_f32 v29, v29
    v_exp_f32 v30, v30
    v_exp_f32 v31, v31
    v_cvt_pk_bf16_f32 v24, v24, v25
    v_cvt_pk_bf16_f32 v25, v26, v27
    v_cvt_pk_bf16_f32 v26, v28, v29
    v_cvt_pk_bf16_f32 v27, v30, v31
    v_exp_f32 v0, v0
    v_exp_f32 v1, v1
    ds_read_b128 v[136:139], v228 offset:2048
    ds_read_b128 v[140:143], v228 offset:2304
    v_mfma_f32_16x16x32_bf16 v[172:175], v[160:163], v[24:27], v[172:175]
    v_exp_f32 v2, v2
    v_mfma_f32_16x16x32_bf16 v[180:183], v[164:167], v[24:27], v[180:183]
    v_exp_f32 v3, v3
    ds_read_b64_tr_b16 v[160:161], v230 offset:1536
    ds_read_b64_tr_b16 v[162:163], v230 offset:1792
    ds_read_b64_tr_b16 v[164:165], v232 offset:1536
    ds_read_b64_tr_b16 v[166:167], v232 offset:1792
    s_waitcnt lgkmcnt(10)
    v_mfma_f32_16x16x32_bf16 v[16:19], v[144:147], v[200:203], 0
    v_exp_f32 v4, v4
    v_mfma_f32_16x16x32_bf16 v[20:23], v[148:151], v[200:203], 0
    v_exp_f32 v5, v5
    s_waitcnt vmcnt(0)
    v_mov_b32 v235, s32
    buffer_store_dword v235, v254, s[16:19], s62 offen sc1
    s_add_u32 s62, s62, 16
    v_mov_b32 v235, s32
    buffer_store_dword v235, v254, s[16:19], s62 offen sc1
    v_exp_f32 v6, v6
    v_exp_f32 v7, v7
    v_cvt_pk_bf16_f32 v0, v0, v1
    v_cvt_pk_bf16_f32 v1, v2, v3
    v_cvt_pk_bf16_f32 v2, v4, v5
    v_cvt_pk_bf16_f32 v3, v6, v7
    v_exp_f32 v8, v8
    v_exp_f32 v9, v9
    s_waitcnt lgkmcnt(6)
    v_mfma_f32_16x16x32_bf16 v[168:171], v[152:155], v[0:3], v[168:171]
    v_exp_f32 v10, v10
    v_mfma_f32_16x16x32_bf16 v[176:179], v[156:159], v[0:3], v[176:179]
    v_exp_f32 v11, v11
    v_mfma_f32_16x16x32_bf16 v[24:27], v[144:147], v[204:207], 0
    v_exp_f32 v12, v12
    v_mfma_f32_16x16x32_bf16 v[28:31], v[148:151], v[204:207], 0
    v_exp_f32 v13, v13
    v_exp_f32 v14, v14
    v_exp_f32 v15, v15
    v_cvt_pk_bf16_f32 v8, v8, v9
    v_cvt_pk_bf16_f32 v9, v10, v11
    v_cvt_pk_bf16_f32 v10, v12, v13
    v_cvt_pk_bf16_f32 v11, v14, v15
    v_exp_f32 v16, v16
    v_exp_f32 v17, v17
    ds_read_b128 v[144:147], v228 offset:2560
    ds_read_b128 v[148:151], v228 offset:2816
    v_mfma_f32_16x16x32_bf16 v[172:175], v[152:155], v[8:11], v[172:175]
    v_exp_f32 v18, v18
    v_mfma_f32_16x16x32_bf16 v[180:183], v[156:159], v[8:11], v[180:183]
    v_exp_f32 v19, v19
    ds_read_b64_tr_b16 v[152:153], v230 offset:2048
    ds_read_b64_tr_b16 v[154:155], v230 offset:2304
    ds_read_b64_tr_b16 v[156:157], v232 offset:2048
    ds_read_b64_tr_b16 v[158:159], v232 offset:2304
    s_waitcnt lgkmcnt(10)
    v_mfma_f32_16x16x32_bf16 v[0:3], v[136:139], v[200:203], 0
    v_exp_f32 v20, v20
    v_mfma_f32_16x16x32_bf16 v[4:7], v[140:143], v[200:203], 0
    v_exp_f32 v21, v21
    v_exp_f32 v22, v22
    v_exp_f32 v23, v23
    v_cvt_pk_bf16_f32 v16, v16, v17
    v_cvt_pk_bf16_f32 v17, v18, v19
    v_cvt_pk_bf16_f32 v18, v20, v21
    v_cvt_pk_bf16_f32 v19, v22, v23
    v_exp_f32 v24, v24
    v_exp_f32 v25, v25
    s_waitcnt lgkmcnt(6)
    v_mfma_f32_16x16x32_bf16 v[168:171], v[160:163], v[16:19], v[168:171]
    v_exp_f32 v26, v26
    v_mfma_f32_16x16x32_bf16 v[176:179], v[164:167], v[16:19], v[176:179]
    v_exp_f32 v27, v27
    v_mfma_f32_16x16x32_bf16 v[8:11], v[136:139], v[204:207], 0
    v_exp_f32 v28, v28
    v_mfma_f32_16x16x32_bf16 v[12:15], v[140:143], v[204:207], 0
    v_exp_f32 v29, v29
    v_exp_f32 v30, v30
    v_exp_f32 v31, v31
    v_cvt_pk_bf16_f32 v24, v24, v25
    v_cvt_pk_bf16_f32 v25, v26, v27
    v_cvt_pk_bf16_f32 v26, v28, v29
    v_cvt_pk_bf16_f32 v27, v30, v31
    v_exp_f32 v0, v0
    v_exp_f32 v1, v1
    ds_read_b128 v[136:139], v228 offset:3072
    ds_read_b128 v[140:143], v228 offset:3328
    v_mfma_f32_16x16x32_bf16 v[172:175], v[160:163], v[24:27], v[172:175]
    v_exp_f32 v2, v2
    v_mfma_f32_16x16x32_bf16 v[180:183], v[164:167], v[24:27], v[180:183]
    v_exp_f32 v3, v3
    ds_read_b64_tr_b16 v[160:161], v230 offset:2560
    ds_read_b64_tr_b16 v[162:163], v230 offset:2816
    ds_read_b64_tr_b16 v[164:165], v232 offset:2560
    ds_read_b64_tr_b16 v[166:167], v232 offset:2816
    s_waitcnt lgkmcnt(10)
    v_mfma_f32_16x16x32_bf16 v[16:19], v[144:147], v[200:203], 0
    v_exp_f32 v4, v4
    v_mfma_f32_16x16x32_bf16 v[20:23], v[148:151], v[200:203], 0
    v_exp_f32 v5, v5
    v_exp_f32 v6, v6
    v_exp_f32 v7, v7
    v_cvt_pk_bf16_f32 v0, v0, v1
    v_cvt_pk_bf16_f32 v1, v2, v3
    v_cvt_pk_bf16_f32 v2, v4, v5
    v_cvt_pk_bf16_f32 v3, v6, v7
    v_exp_f32 v8, v8
    v_exp_f32 v9, v9
    s_waitcnt lgkmcnt(6)
    v_mfma_f32_16x16x32_bf16 v[168:171], v[152:155], v[0:3], v[168:171]
    v_exp_f32 v10, v10
    v_mfma_f32_16x16x32_bf16 v[176:179], v[156:159], v[0:3], v[176:179]
    v_exp_f32 v11, v11
    v_mfma_f32_16x16x32_bf16 v[24:27], v[144:147], v[204:207], 0
    v_exp_f32 v12, v12
    v_mfma_f32_16x16x32_bf16 v[28:31], v[148:151], v[204:207], 0
    v_exp_f32 v13, v13
    v_exp_f32 v14, v14
    v_exp_f32 v15, v15
    v_cvt_pk_bf16_f32 v8, v8, v9
    v_cvt_pk_bf16_f32 v9, v10, v11
    v_cvt_pk_bf16_f32 v10, v12, v13
    v_cvt_pk_bf16_f32 v11, v14, v15
    v_exp_f32 v16, v16
    v_exp_f32 v17, v17
    ds_read_b128 v[144:147], v228 offset:3584
    ds_read_b128 v[148:151], v228 offset:3840
    v_mfma_f32_16x16x32_bf16 v[172:175], v[152:155], v[8:11], v[172:175]
    v_exp_f32 v18, v18
    v_mfma_f32_16x16x32_bf16 v[180:183], v[156:159], v[8:11], v[180:183]
    v_exp_f32 v19, v19
    ds_read_b64_tr_b16 v[152:153], v230 offset:3072
    ds_read_b64_tr_b16 v[154:155], v230 offset:3328
    ds_read_b64_tr_b16 v[156:157], v232 offset:3072
    ds_read_b64_tr_b16 v[158:159], v232 offset:3328
    s_waitcnt lgkmcnt(10)
    v_mfma_f32_16x16x32_bf16 v[0:3], v[136:139], v[200:203], 0
    v_exp_f32 v20, v20
    v_mfma_f32_16x16x32_bf16 v[4:7], v[140:143], v[200:203], 0
    v_exp_f32 v21, v21
    v_exp_f32 v22, v22
    v_exp_f32 v23, v23
    v_cvt_pk_bf16_f32 v16, v16, v17
    v_cvt_pk_bf16_f32 v17, v18, v19
    v_cvt_pk_bf16_f32 v18, v20, v21
    v_cvt_pk_bf16_f32 v19, v22, v23
    v_exp_f32 v24, v24
    v_exp_f32 v25, v25
    s_waitcnt lgkmcnt(6)
    v_mfma_f32_16x16x32_bf16 v[168:171], v[160:163], v[16:19], v[168:171]
    v_exp_f32 v26, v26
    v_mfma_f32_16x16x32_bf16 v[176:179], v[164:167], v[16:19], v[176:179]
    v_exp_f32 v27, v27
    v_mfma_f32_16x16x32_bf16 v[8:11], v[136:139], v[204:207], 0
    v_exp_f32 v28, v28
    v_mfma_f32_16x16x32_bf16 v[12:15], v[140:143], v[204:207], 0
    v_exp_f32 v29, v29
    v_exp_f32 v30, v30
    v_exp_f32 v31, v31
    v_cvt_pk_bf16_f32 v24, v24, v25
    v_cvt_pk_bf16_f32 v25, v26, v27
    v_cvt_pk_bf16_f32 v26, v28, v29
    v_cvt_pk_bf16_f32 v27, v30, v31
    v_exp_f32 v0, v0
    v_exp_f32 v1, v1
    ds_read_b128 v[136:139], v228 offset:4096
    ds_read_b128 v[140:143], v228 offset:4352
    v_mfma_f32_16x16x32_bf16 v[172:175], v[160:163], v[24:27], v[172:175]
    v_exp_f32 v2, v2
    v_mfma_f32_16x16x32_bf16 v[180:183], v[164:167], v[24:27], v[180:183]
    v_exp_f32 v3, v3
    ds_read_b64_tr_b16 v[160:161], v230 offset:3584
    ds_read_b64_tr_b16 v[162:163], v230 offset:3840
    ds_read_b64_tr_b16 v[164:165], v232 offset:3584
    ds_read_b64_tr_b16 v[166:167], v232 offset:3840
    s_waitcnt lgkmcnt(10)
    v_mfma_f32_16x16x32_bf16 v[16:19], v[144:147], v[200:203], 0
    v_exp_f32 v4, v4
    v_mfma_f32_16x16x32_bf16 v[20:23], v[148:151], v[200:203], 0
    v_exp_f32 v5, v5
    v_exp_f32 v6, v6
    v_exp_f32 v7, v7
    v_cvt_pk_bf16_f32 v0, v0, v1
    v_cvt_pk_bf16_f32 v1, v2, v3
    v_cvt_pk_bf16_f32 v2, v4, v5
    v_cvt_pk_bf16_f32 v3, v6, v7
    v_exp_f32 v8, v8
    v_exp_f32 v9, v9
    s_waitcnt lgkmcnt(6)
    v_mfma_f32_16x16x32_bf16 v[168:171], v[152:155], v[0:3], v[168:171]
    v_exp_f32 v10, v10
    v_mfma_f32_16x16x32_bf16 v[176:179], v[156:159], v[0:3], v[176:179]
    v_exp_f32 v11, v11
    v_mfma_f32_16x16x32_bf16 v[24:27], v[144:147], v[204:207], 0
    v_exp_f32 v12, v12
    v_mfma_f32_16x16x32_bf16 v[28:31], v[148:151], v[204:207], 0
    v_exp_f32 v13, v13
    v_exp_f32 v14, v14
    v_exp_f32 v15, v15
    v_cvt_pk_bf16_f32 v8, v8, v9
    v_cvt_pk_bf16_f32 v9, v10, v11
    v_cvt_pk_bf16_f32 v10, v12, v13
    v_cvt_pk_bf16_f32 v11, v14, v15
    v_exp_f32 v16, v16
    v_exp_f32 v17, v17
    ds_read_b128 v[144:147], v229 offset:0
    ds_read_b128 v[148:151], v229 offset:256
    v_mfma_f32_16x16x32_bf16 v[172:175], v[152:155], v[8:11], v[172:175]
    v_exp_f32 v18, v18
    v_mfma_f32_16x16x32_bf16 v[180:183], v[156:159], v[8:11], v[180:183]
    v_exp_f32 v19, v19
    ds_read_b64_tr_b16 v[152:153], v230 offset:4096
    ds_read_b64_tr_b16 v[154:155], v230 offset:4352
    ds_read_b64_tr_b16 v[156:157], v232 offset:4096
    ds_read_b64_tr_b16 v[158:159], v232 offset:4352
    s_waitcnt lgkmcnt(10)
    v_mfma_f32_16x16x32_bf16 v[0:3], v[136:139], v[200:203], v[216:219]
    v_exp_f32 v20, v20
    v_exp_f32 v21, v21
    v_exp_f32 v22, v22
    v_exp_f32 v23, v23
    v_cvt_pk_bf16_f32 v16, v16, v17
    v_cvt_pk_bf16_f32 v17, v18, v19
    v_cvt_pk_bf16_f32 v18, v20, v21
    v_cvt_pk_bf16_f32 v19, v22, v23
    v_exp_f32 v24, v24
    v_exp_f32 v25, v25
    s_waitcnt lgkmcnt(6)
    v_mfma_f32_16x16x32_bf16 v[168:171], v[160:163], v[16:19], v[168:171]
    v_exp_f32 v26, v26
    v_mfma_f32_16x16x32_bf16 v[176:179], v[164:167], v[16:19], v[176:179]
    v_exp_f32 v27, v27
    v_mfma_f32_16x16x32_bf16 v[8:11], v[136:139], v[204:207], 0
    v_exp_f32 v28, v28
    v_mfma_f32_16x16x32_bf16 v[12:15], v[140:143], v[204:207], v[216:219]
    v_exp_f32 v29, v29
    v_exp_f32 v30, v30
    v_exp_f32 v31, v31
    v_cvt_pk_bf16_f32 v24, v24, v25
    v_cvt_pk_bf16_f32 v25, v26, v27
    v_cvt_pk_bf16_f32 v26, v28, v29
    v_cvt_pk_bf16_f32 v27, v30, v31
    v_exp_f32 v0, v0
    v_exp_f32 v1, v1
    ds_read_b128 v[136:139], v229 offset:512
    ds_read_b128 v[140:143], v229 offset:768
    v_mfma_f32_16x16x32_bf16 v[172:175], v[160:163], v[24:27], v[172:175]
    v_exp_f32 v2, v2
    v_mfma_f32_16x16x32_bf16 v[180:183], v[164:167], v[24:27], v[180:183]
    v_exp_f32 v3, v3
    ds_read_b64_tr_b16 v[160:161], v231 offset:0
    ds_read_b64_tr_b16 v[162:163], v231 offset:256
    ds_read_b64_tr_b16 v[164:165], v233 offset:0
    ds_read_b64_tr_b16 v[166:167], v233 offset:256
    s_waitcnt lgkmcnt(10)
    v_mfma_f32_16x16x32_bf16 v[16:19], v[144:147], v[208:211], v[220:223]
    v_cvt_pk_bf16_f32 v0, v0, v1
    v_mfma_f32_16x16x32_bf16 v[20:23], v[148:151], v[208:211], 0
    v_cvt_pk_bf16_f32 v1, v2, v3
    v_exp_f32 v8, v8
    v_exp_f32 v9, v9
    s_waitcnt lgkmcnt(6)
    v_mfma_f32_16x16x16_bf16 v[168:171], v[152:153], v[0:1], v[168:171]
    v_exp_f32 v10, v10
    v_mfma_f32_16x16x16_bf16 v[176:179], v[156:157], v[0:1], v[176:179]
    v_exp_f32 v11, v11
    v_mfma_f32_16x16x32_bf16 v[24:27], v[148:151], v[212:215], v[220:223]
    v_exp_f32 v12, v12
    v_exp_f32 v13, v13
    v_exp_f32 v14, v14
    v_exp_f32 v15, v15
    v_cvt_pk_bf16_f32 v8, v8, v9
    v_cvt_pk_bf16_f32 v9, v10, v11
    v_cvt_pk_bf16_f32 v10, v12, v13
    v_cvt_pk_bf16_f32 v11, v14, v15
    v_exp_f32 v16, v16
    v_exp_f32 v17, v17
    ds_read_b128 v[144:147], v229 offset:1024
    ds_read_b128 v[148:151], v229 offset:1280
    v_mfma_f32_16x16x32_bf16 v[172:175], v[152:155], v[8:11], v[172:175]
    v_exp_f32 v18, v18
    v_mfma_f32_16x16x32_bf16 v[180:183], v[156:159], v[8:11], v[180:183]
    v_exp_f32 v19, v19
    ds_read_b64_tr_b16 v[152:153], v231 offset:512
    ds_read_b64_tr_b16 v[154:155], v231 offset:768
    ds_read_b64_tr_b16 v[156:157], v233 offset:512
    ds_read_b64_tr_b16 v[158:159], v233 offset:768
    s_waitcnt lgkmcnt(10)
    v_mfma_f32_16x16x32_bf16 v[0:3], v[136:139], v[208:211], 0
    v_exp_f32 v20, v20
    v_mfma_f32_16x16x32_bf16 v[4:7], v[140:143], v[208:211], 0
    v_exp_f32 v21, v21
    v_exp_f32 v22, v22
    v_exp_f32 v23, v23
    v_cvt_pk_bf16_f32 v16, v16, v17
    v_cvt_pk_bf16_f32 v17, v18, v19
    v_cvt_pk_bf16_f32 v18, v20, v21
    v_cvt_pk_bf16_f32 v19, v22, v23
    v_exp_f32 v24, v24
    v_exp_f32 v25, v25
    s_waitcnt lgkmcnt(6)
    v_mfma_f32_16x16x32_bf16 v[184:187], v[160:163], v[16:19], 0
    v_exp_f32 v26, v26
    v_mfma_f32_16x16x32_bf16 v[192:195], v[164:167], v[16:19], 0
    v_exp_f32 v27, v27
    v_mfma_f32_16x16x32_bf16 v[8:11], v[136:139], v[212:215], 0
    v_cvt_pk_bf16_f32 v24, v24, v25
    v_mfma_f32_16x16x32_bf16 v[12:15], v[140:143], v[212:215], 0
    v_cvt_pk_bf16_f32 v25, v26, v27
    v_exp_f32 v0, v0
    v_exp_f32 v1, v1
    ds_read_b128 v[136:139], v229 offset:1536
    ds_read_b128 v[140:143], v229 offset:1792
    v_mfma_f32_16x16x16_bf16 v[188:191], v[162:163], v[24:25], 0
    v_exp_f32 v2, v2
    v_mfma_f32_16x16x16_bf16 v[196:199], v[166:167], v[24:25], 0
    v_exp_f32 v3, v3
    ds_read_b64_tr_b16 v[160:161], v231 offset:1024
    ds_read_b64_tr_b16 v[162:163], v231 offset:1280
    ds_read_b64_tr_b16 v[164:165], v233 offset:1024
    ds_read_b64_tr_b16 v[166:167], v233 offset:1280
    s_waitcnt lgkmcnt(10)
    v_mfma_f32_16x16x32_bf16 v[16:19], v[144:147], v[208:211], 0
    v_exp_f32 v4, v4
    v_mfma_f32_16x16x32_bf16 v[20:23], v[148:151], v[208:211], 0
    v_mov_b32 v236, v176
    v_exp_f32 v5, v5
    v_mov_b32 v237, v176
    v_exp_f32 v6, v6
    v_mov_b32 v238, v180
    v_exp_f32 v7, v7
    v_mov_b32 v239, v180
    v_cvt_pk_bf16_f32 v0, v0, v1
    s_nop 0
    v_cvt_pk_bf16_f32 v1, v2, v3
    v_permlane32_swap_b32 v236, v237
    v_cvt_pk_bf16_f32 v2, v4, v5
    v_cvt_pk_bf16_f32 v3, v6, v7
    v_permlane32_swap_b32 v238, v239
    v_exp_f32 v8, v8
    v_exp_f32 v9, v9
    s_waitcnt lgkmcnt(6)
    v_mfma_f32_16x16x32_bf16 v[184:187], v[152:155], v[0:3], v[184:187]
    v_exp_f32 v10, v10
    v_mfma_f32_16x16x32_bf16 v[192:195], v[156:159], v[0:3], v[192:195]
    v_exp_f32 v11, v11
    v_mfma_f32_16x16x32_bf16 v[24:27], v[144:147], v[212:215], 0
    v_exp_f32 v12, v12
    v_mfma_f32_16x16x32_bf16 v[28:31], v[148:151], v[212:215], 0
    v_exp_f32 v13, v13
    v_rcp_f32 v236, v237
    v_exp_f32 v14, v14
    v_exp_f32 v15, v15
    v_rcp_f32 v238, v239
    v_cvt_pk_bf16_f32 v8, v8, v9
    v_cvt_pk_bf16_f32 v9, v10, v11
    v_mul_f32 v168, v168, v236
    v_cvt_pk_bf16_f32 v10, v12, v13
    v_mul_f32 v169, v169, v236
    v_cvt_pk_bf16_f32 v11, v14, v15
    v_mul_f32 v170, v170, v236
    v_exp_f32 v16, v16
    v_exp_f32 v17, v17
    ds_read_b128 v[144:147], v229 offset:2048
    ds_read_b128 v[148:151], v229 offset:2304
    v_mfma_f32_16x16x32_bf16 v[188:191], v[152:155], v[8:11], v[188:191]
    v_exp_f32 v18, v18
    v_mfma_f32_16x16x32_bf16 v[196:199], v[156:159], v[8:11], v[196:199]
    v_exp_f32 v19, v19
    ds_read_b64_tr_b16 v[152:153], v231 offset:1536
    ds_read_b64_tr_b16 v[154:155], v231 offset:1792
    ds_read_b64_tr_b16 v[156:157], v233 offset:1536
    ds_read_b64_tr_b16 v[158:159], v233 offset:1792
    s_waitcnt lgkmcnt(10)
    v_mfma_f32_16x16x32_bf16 v[0:3], v[136:139], v[208:211], 0
    v_exp_f32 v20, v20
    v_mfma_f32_16x16x32_bf16 v[4:7], v[140:143], v[208:211], 0
    v_mul_f32 v171, v171, v236
    v_exp_f32 v21, v21
    v_mul_f32 v172, v172, v238
    v_exp_f32 v22, v22
    v_mul_f32 v173, v173, v238
    v_exp_f32 v23, v23
    v_mul_f32 v174, v174, v238
    v_cvt_pk_bf16_f32 v16, v16, v17
    v_mul_f32 v175, v175, v238
    v_cvt_pk_bf16_f32 v17, v18, v19
    v_mul_f32 v176, v176, v236
    v_cvt_pk_bf16_f32 v18, v20, v21
    v_mul_f32 v177, v177, v236
    v_cvt_pk_bf16_f32 v19, v22, v23
    v_mul_f32 v178, v178, v236
    v_exp_f32 v24, v24
    v_exp_f32 v25, v25
    s_waitcnt lgkmcnt(6)
    v_mfma_f32_16x16x32_bf16 v[184:187], v[160:163], v[16:19], v[184:187]
    v_exp_f32 v26, v26
    v_mfma_f32_16x16x32_bf16 v[192:195], v[164:167], v[16:19], v[192:195]
    v_exp_f32 v27, v27
    v_mfma_f32_16x16x32_bf16 v[8:11], v[136:139], v[212:215], 0
    v_exp_f32 v28, v28
    v_mfma_f32_16x16x32_bf16 v[12:15], v[140:143], v[212:215], 0
    v_mul_f32 v179, v179, v236
    v_exp_f32 v29, v29
    v_mul_f32 v180, v180, v238
    v_exp_f32 v30, v30
    v_mul_f32 v181, v181, v238
    v_exp_f32 v31, v31
    v_mul_f32 v182, v182, v238
    v_cvt_pk_bf16_f32 v24, v24, v25
    v_mul_f32 v183, v183, v238
    v_cvt_pk_bf16_f32 v25, v26, v27
    v_cvt_pk_bf16_f32 v168, v168, v169
    v_cvt_pk_bf16_f32 v26, v28, v29
    v_cvt_pk_bf16_f32 v169, v170, v171
    v_cvt_pk_bf16_f32 v27, v30, v31
    v_cvt_pk_bf16_f32 v170, v172, v173
    v_exp_f32 v0, v0
    v_exp_f32 v1, v1
    ds_read_b128 v[136:139], v229 offset:2560
    ds_read_b128 v[140:143], v229 offset:2816
    v_mfma_f32_16x16x32_bf16 v[188:191], v[160:163], v[24:27], v[188:191]
    v_exp_f32 v2, v2
    v_mfma_f32_16x16x32_bf16 v[196:199], v[164:167], v[24:27], v[196:199]
    v_exp_f32 v3, v3
    ds_read_b64_tr_b16 v[160:161], v231 offset:2048
    ds_read_b64_tr_b16 v[162:163], v231 offset:2304
    ds_read_b64_tr_b16 v[164:165], v233 offset:2048
    ds_read_b64_tr_b16 v[166:167], v233 offset:2304
    s_waitcnt lgkmcnt(10)
    v_mfma_f32_16x16x32_bf16 v[16:19], v[144:147], v[208:211], 0
    v_exp_f32 v4, v4
    v_mfma_f32_16x16x32_bf16 v[20:23], v[148:151], v[208:211], 0
    v_cvt_pk_bf16_f32 v171, v174, v175
    v_exp_f32 v5, v5
    v_cvt_pk_bf16_f32 v176, v176, v177
    v_exp_f32 v6, v6
    v_cvt_pk_bf16_f32 v177, v178, v179
    v_exp_f32 v7, v7
    v_cvt_pk_bf16_f32 v178, v180, v181
    v_cvt_pk_bf16_f32 v0, v0, v1
    v_cvt_pk_bf16_f32 v179, v182, v183
    v_cvt_pk_bf16_f32 v1, v2, v3
    v_permlane16_swap_b32 v168, v170
    v_cvt_pk_bf16_f32 v2, v4, v5
    v_cvt_pk_bf16_f32 v3, v6, v7
    v_permlane16_swap_b32 v169, v171
    v_exp_f32 v8, v8
    v_exp_f32 v9, v9
    s_waitcnt lgkmcnt(6)
    v_mfma_f32_16x16x32_bf16 v[184:187], v[152:155], v[0:3], v[184:187]
    v_exp_f32 v10, v10
    v_mfma_f32_16x16x32_bf16 v[192:195], v[156:159], v[0:3], v[192:195]
    v_exp_f32 v11, v11
    v_mfma_f32_16x16x32_bf16 v[24:27], v[144:147], v[212:215], 0
    v_exp_f32 v12, v12
    v_mfma_f32_16x16x32_bf16 v[28:31], v[148:151], v[212:215], 0
    v_exp_f32 v13, v13
    s_add_u32 s47, s58, 0
    v_exp_f32 v14, v14
    buffer_store_dwordx4 v[168:171], v252, s[16:19], s47 offen sc1
    v_exp_f32 v15, v15
    v_cvt_pk_bf16_f32 v8, v8, v9
    v_cvt_pk_bf16_f32 v9, v10, v11
    v_cvt_pk_bf16_f32 v10, v12, v13
    v_cvt_pk_bf16_f32 v11, v14, v15
    v_exp_f32 v16, v16
    v_exp_f32 v17, v17
    ds_read_b128 v[144:147], v229 offset:3072
    ds_read_b128 v[148:151], v229 offset:3328
    v_mfma_f32_16x16x32_bf16 v[188:191], v[152:155], v[8:11], v[188:191]
    v_exp_f32 v18, v18
    v_mfma_f32_16x16x32_bf16 v[196:199], v[156:159], v[8:11], v[196:199]
    v_exp_f32 v19, v19
    ds_read_b64_tr_b16 v[152:153], v231 offset:2560
    ds_read_b64_tr_b16 v[154:155], v231 offset:2816
    ds_read_b64_tr_b16 v[156:157], v233 offset:2560
    ds_read_b64_tr_b16 v[158:159], v233 offset:2816
    s_waitcnt lgkmcnt(10)
    v_mfma_f32_16x16x32_bf16 v[0:3], v[136:139], v[208:211], 0
    v_exp_f32 v20, v20
    v_mfma_f32_16x16x32_bf16 v[4:7], v[140:143], v[208:211], 0
    v_exp_f32 v21, v21
    v_exp_f32 v22, v22
    v_exp_f32 v23, v23
    v_cvt_pk_bf16_f32 v16, v16, v17
    v_cvt_pk_bf16_f32 v17, v18, v19
    v_cvt_pk_bf16_f32 v18, v20, v21
    v_cvt_pk_bf16_f32 v19, v22, v23
    v_exp_f32 v24, v24
    v_exp_f32 v25, v25
    s_waitcnt lgkmcnt(6)
    v_mfma_f32_16x16x32_bf16 v[184:187], v[160:163], v[16:19], v[184:187]
    v_exp_f32 v26, v26
    v_mfma_f32_16x16x32_bf16 v[192:195], v[164:167], v[16:19], v[192:195]
    v_exp_f32 v27, v27
    v_mfma_f32_16x16x32_bf16 v[8:11], v[136:139], v[212:215], 0
    v_exp_f32 v28, v28
    v_mfma_f32_16x16x32_bf16 v[12:15], v[140:143], v[212:215], 0
    v_exp_f32 v29, v29
    v_exp_f32 v30, v30
    v_exp_f32 v31, v31
    v_cvt_pk_bf16_f32 v24, v24, v25
    v_cvt_pk_bf16_f32 v25, v26, v27
    v_cvt_pk_bf16_f32 v26, v28, v29
    v_cvt_pk_bf16_f32 v27, v30, v31
    v_exp_f32 v0, v0
    v_exp_f32 v1, v1
    ds_read_b128 v[136:139], v229 offset:3584
    ds_read_b128 v[140:143], v229 offset:3840
    v_mfma_f32_16x16x32_bf16 v[188:191], v[160:163], v[24:27], v[188:191]
    v_exp_f32 v2, v2
    v_mfma_f32_16x16x32_bf16 v[196:199], v[164:167], v[24:27], v[196:199]
    v_exp_f32 v3, v3
    ds_read_b64_tr_b16 v[160:161], v231 offset:3072
    ds_read_b64_tr_b16 v[162:163], v231 offset:3328
    ds_read_b64_tr_b16 v[164:165], v233 offset:3072
    ds_read_b64_tr_b16 v[166:167], v233 offset:3328
    s_waitcnt lgkmcnt(10)
    v_mfma_f32_16x16x32_bf16 v[16:19], v[144:147], v[208:211], 0
    v_exp_f32 v4, v4
    v_mfma_f32_16x16x32_bf16 v[20:23], v[148:151], v[208:211], 0
    v_exp_f32 v5, v5
    v_exp_f32 v6, v6
    v_exp_f32 v7, v7
    v_cvt_pk_bf16_f32 v0, v0, v1
    v_cvt_pk_bf16_f32 v1, v2, v3
    v_cvt_pk_bf16_f32 v2, v4, v5
    v_cvt_pk_bf16_f32 v3, v6, v7
    v_exp_f32 v8, v8
    v_exp_f32 v9, v9
    s_waitcnt lgkmcnt(6)
    v_mfma_f32_16x16x32_bf16 v[184:187], v[152:155], v[0:3], v[184:187]
    v_exp_f32 v10, v10
    v_mfma_f32_16x16x32_bf16 v[192:195], v[156:159], v[0:3], v[192:195]
    v_exp_f32 v11, v11
    v_mfma_f32_16x16x32_bf16 v[24:27], v[144:147], v[212:215], 0
    v_exp_f32 v12, v12
    v_mfma_f32_16x16x32_bf16 v[28:31], v[148:151], v[212:215], 0
    v_exp_f32 v13, v13
    v_exp_f32 v14, v14
    v_exp_f32 v15, v15
    v_cvt_pk_bf16_f32 v8, v8, v9
    v_cvt_pk_bf16_f32 v9, v10, v11
    v_cvt_pk_bf16_f32 v10, v12, v13
    v_cvt_pk_bf16_f32 v11, v14, v15
    v_exp_f32 v16, v16
    v_exp_f32 v17, v17
    ds_read_b128 v[144:147], v229 offset:4096
    ds_read_b128 v[148:151], v229 offset:4352
    v_mfma_f32_16x16x32_bf16 v[188:191], v[152:155], v[8:11], v[188:191]
    v_exp_f32 v18, v18
    v_mfma_f32_16x16x32_bf16 v[196:199], v[156:159], v[8:11], v[196:199]
    v_exp_f32 v19, v19
    ds_read_b64_tr_b16 v[152:153], v231 offset:3584
    ds_read_b64_tr_b16 v[154:155], v231 offset:3840
    ds_read_b64_tr_b16 v[156:157], v233 offset:3584
    ds_read_b64_tr_b16 v[158:159], v233 offset:3840
    s_waitcnt lgkmcnt(10)
    v_mfma_f32_16x16x32_bf16 v[0:3], v[136:139], v[208:211], 0
    v_exp_f32 v20, v20
    v_mfma_f32_16x16x32_bf16 v[4:7], v[140:143], v[208:211], 0
    v_exp_f32 v21, v21
    v_exp_f32 v22, v22
    v_exp_f32 v23, v23
    v_cvt_pk_bf16_f32 v16, v16, v17
    v_cvt_pk_bf16_f32 v17, v18, v19
    v_cvt_pk_bf16_f32 v18, v20, v21
    v_cvt_pk_bf16_f32 v19, v22, v23
    v_exp_f32 v24, v24
    v_exp_f32 v25, v25
    s_waitcnt lgkmcnt(6)
    v_mfma_f32_16x16x32_bf16 v[184:187], v[160:163], v[16:19], v[184:187]
    v_exp_f32 v26, v26
    v_mfma_f32_16x16x32_bf16 v[192:195], v[164:167], v[16:19], v[192:195]
    v_exp_f32 v27, v27
    v_mfma_f32_16x16x32_bf16 v[8:11], v[136:139], v[212:215], 0
    v_exp_f32 v28, v28
    v_mfma_f32_16x16x32_bf16 v[12:15], v[140:143], v[212:215], 0
    v_exp_f32 v29, v29
    v_exp_f32 v30, v30
    v_exp_f32 v31, v31
    v_cvt_pk_bf16_f32 v24, v24, v25
    v_cvt_pk_bf16_f32 v25, v26, v27
    v_cvt_pk_bf16_f32 v26, v28, v29
    v_cvt_pk_bf16_f32 v27, v30, v31
    v_exp_f32 v0, v0
    v_exp_f32 v1, v1
    v_mfma_f32_16x16x32_bf16 v[188:191], v[160:163], v[24:27], v[188:191]
    v_exp_f32 v2, v2
    v_mfma_f32_16x16x32_bf16 v[196:199], v[164:167], v[24:27], v[196:199]
    v_exp_f32 v3, v3
    ds_read_b64_tr_b16 v[160:161], v231 offset:4096
    ds_read_b64_tr_b16 v[162:163], v231 offset:4352
    ds_read_b64_tr_b16 v[164:165], v233 offset:4096
    ds_read_b64_tr_b16 v[166:167], v233 offset:4352
    s_waitcnt lgkmcnt(8)
    v_mfma_f32_16x16x32_bf16 v[16:19], v[144:147], v[208:211], v[216:219]
    v_exp_f32 v4, v4
    v_exp_f32 v5, v5
    v_exp_f32 v6, v6
    v_exp_f32 v7, v7
    v_cvt_pk_bf16_f32 v0, v0, v1
    v_cvt_pk_bf16_f32 v1, v2, v3
    v_cvt_pk_bf16_f32 v2, v4, v5
    v_cvt_pk_bf16_f32 v3, v6, v7
    v_exp_f32 v8, v8
    v_exp_f32 v9, v9
    s_waitcnt lgkmcnt(4)
    v_mfma_f32_16x16x32_bf16 v[184:187], v[152:155], v[0:3], v[184:187]
    v_exp_f32 v10, v10
    v_mfma_f32_16x16x32_bf16 v[192:195], v[156:159], v[0:3], v[192:195]
    v_exp_f32 v11, v11
    v_mfma_f32_16x16x32_bf16 v[24:27], v[144:147], v[212:215], 0
    v_exp_f32 v12, v12
    v_mfma_f32_16x16x32_bf16 v[28:31], v[148:151], v[212:215], v[216:219]
    v_exp_f32 v13, v13
    v_exp_f32 v14, v14
    v_exp_f32 v15, v15
    v_cvt_pk_bf16_f32 v8, v8, v9
    v_cvt_pk_bf16_f32 v9, v10, v11
    v_cvt_pk_bf16_f32 v10, v12, v13
    v_cvt_pk_bf16_f32 v11, v14, v15
    v_exp_f32 v16, v16
    v_exp_f32 v17, v17
    v_mfma_f32_16x16x32_bf16 v[188:191], v[152:155], v[8:11], v[188:191]
    v_exp_f32 v18, v18
    v_mfma_f32_16x16x32_bf16 v[196:199], v[156:159], v[8:11], v[196:199]
    v_exp_f32 v19, v19
    v_cvt_pk_bf16_f32 v16, v16, v17
    v_cvt_pk_bf16_f32 v17, v18, v19
    v_exp_f32 v24, v24
    v_exp_f32 v25, v25
    s_waitcnt lgkmcnt(0)
    v_mfma_f32_16x16x16_bf16 v[184:187], v[160:161], v[16:17], v[184:187]
    v_exp_f32 v26, v26
    v_mfma_f32_16x16x16_bf16 v[192:195], v[164:165], v[16:17], v[192:195]
    v_exp_f32 v27, v27
    v_exp_f32 v28, v28
    v_exp_f32 v29, v29
    v_exp_f32 v30, v30
    v_exp_f32 v31, v31
    v_cvt_pk_bf16_f32 v24, v24, v25
    v_cvt_pk_bf16_f32 v25, v26, v27
    v_cvt_pk_bf16_f32 v26, v28, v29
    v_cvt_pk_bf16_f32 v27, v30, v31
    s_nop 1
    v_mfma_f32_16x16x32_bf16 v[188:191], v[160:163], v[24:27], v[188:191]
    v_mfma_f32_16x16x32_bf16 v[196:199], v[164:167], v[24:27], v[196:199]
    v_mov_b32 v240, v192
    v_mov_b32 v241, v192
    s_nop 5
    v_mov_b32 v242, v196
    v_mov_b32 v243, v196
    s_nop 0
    v_permlane32_swap_b32 v240, v241
    v_permlane32_swap_b32 v242, v243
    v_rcp_f32 v240, v241
    v_rcp_f32 v242, v243
    v_mul_f32 v184, v184, v240
    v_mul_f32 v185, v185, v240
    v_mul_f32 v186, v186, v240
    v_mul_f32 v187, v187, v240
    v_mul_f32 v188, v188, v242
    v_mul_f32 v189, v189, v242
    v_mul_f32 v190, v190, v242
    v_mul_f32 v191, v191, v242
    v_mul_f32 v192, v192, v240
    v_mul_f32 v193, v193, v240
    v_mul_f32 v194, v194, v240
    v_mul_f32 v195, v195, v240
    v_mul_f32 v196, v196, v242
    v_mul_f32 v197, v197, v242
    v_mul_f32 v198, v198, v242
    v_mul_f32 v199, v199, v242
    v_cvt_pk_bf16_f32 v184, v184, v185
    v_cvt_pk_bf16_f32 v185, v186, v187
    v_cvt_pk_bf16_f32 v186, v188, v189
    v_cvt_pk_bf16_f32 v187, v190, v191
    v_cvt_pk_bf16_f32 v192, v192, v193
    v_cvt_pk_bf16_f32 v193, v194, v195
    v_cvt_pk_bf16_f32 v194, v196, v197
    v_cvt_pk_bf16_f32 v195, v198, v199
    v_permlane16_swap_b32 v184, v186
    v_permlane16_swap_b32 v185, v187
    s_add_u32 s47, s58, 6144
    buffer_store_dwordx4 v[184:187], v252, s[16:19], s47 offen sc1
    v_cndmask_b32 v192, v192, v176, s[78:79]
    v_cndmask_b32 v193, v193, v177, s[78:79]
    v_cndmask_b32 v194, v194, v178, s[78:79]
    v_cndmask_b32 v195, v195, v179, s[78:79]
    s_add_u32 s47, s58, 4096
    v_permlane16_swap_b32 v192, v194
    v_permlane16_swap_b32 v193, v195
    buffer_store_dwordx4 v[192:195], v234, s[16:19], s47 offen sc1
    v_min3_f32 v0, v237, v239, v241
    v_max3_f32 v1, v237, v239, v241
    v_min_f32 v0, v0, v243
    v_max_f32 v1, v1, v243
    v_cmp_nle_f32 vcc, 0x21800000, v0
    v_mov_b32 v2, 0x4b800000
    v_cmp_nge_f32 s[74:75], v2, v1
    s_nop 0
    s_or_b64 vcc, vcc, s[74:75]
    s_cbranch_vccnz L_true_max
L_att_done:
    s_lshl_b32 s47, s36, 4
    s_add_u32 s47, s47, s38
    s_lshl_b32 s47, s47, 7
    s_lshl_b32 s48, s33, 2
    s_add_u32 s47, s47, s48
    s_add_u32 s47, s47, 0x21000
    s_waitcnt vmcnt(0)
    v_mov_b32 v235, s32
    buffer_store_dword v235, v254, s[16:19], s47 offen sc1
    s_setprio 0
    v_mbcnt_lo_u32_b32 v100, -1, 0
    v_mbcnt_hi_u32_b32 v100, -1, v100
    s_lshl_b32 s46, s82, 6
    s_lshl_b32 s47, s33, 3
    s_add_u32 s46, s46, s47
    s_mul_i32 s46, s46, 1280
    s_mul_i32 s48, s83, 160
    s_add_u32 s46, s46, s48
    s_mul_i32 s47, s47, 336
    v_add_u32 v101, 0, v100
    v_mul_u32_u24 v102, 0xccd, v101
    v_lshrrev_b32 v102, 16, v102
    v_mul_u32_u24 v103, 20, v102
    v_sub_u32 v103, v101, v103
    v_mul_u32_u24 v246, 336, v102
    v_lshl_add_u32 v246, v103, 4, v246
    v_add_u32 v246, s47, v246
    v_mul_u32_u24 v251, 0x500, v102
    v_lshl_add_u32 v251, v103, 3, v251
    v_add_u32 v251, s46, v251
    v_add_u32 v101, 64, v100
    v_mul_u32_u24 v102, 0xccd, v101
    v_lshrrev_b32 v102, 16, v102
    v_mul_u32_u24 v103, 20, v102
    v_sub_u32 v103, v101, v103
    v_mul_u32_u24 v245, 336, v102
    v_lshl_add_u32 v245, v103, 4, v245
    v_add_u32 v245, s47, v245
    v_mul_u32_u24 v252, 0x500, v102
    v_lshl_add_u32 v252, v103, 3, v252
    v_add_u32 v252, s46, v252
    v_add_u32 v101, 128, v100
    v_mul_u32_u24 v102, 0xccd, v101
    v_lshrrev_b32 v102, 16, v102
    v_mul_u32_u24 v103, 20, v102
    v_sub_u32 v103, v101, v103
    v_mul_u32_u24 v250, 336, v102
    v_lshl_add_u32 v250, v103, 4, v250
    v_add_u32 v250, s47, v250
    v_mul_u32_u24 v253, 0x500, v102
    v_lshl_add_u32 v253, v103, 3, v253
    v_add_u32 v253, s46, v253
    v_cmp_gt_u32 vcc, 32, v100
    v_mov_b32 v102, 0x80000000
    s_nop 0
    v_cndmask_b32 v253, v102, v253, vcc
    v_cndmask_b32 v250, 0, v250, vcc
    buffer_load_dwordx2 v[80:81], v251, s[4:7], 0 offen
    buffer_load_dwordx2 v[82:83], v252, s[4:7], 0 offen
    buffer_load_dwordx2 v[84:85], v253, s[4:7], 0 offen
    s_or_b32 s46, s2, s33
    s_cmp_lg_u32 s46, 0
    s_cbranch_scc1 L_epd_44
    v_mbcnt_lo_u32_b32 v40, -1, 0
    v_mbcnt_hi_u32_b32 v40, -1, v40
    v_lshrrev_b32 v41, 4, v40
    v_and_b32 v40, 15, v40
    v_lshlrev_b32 v40, 7, v40
    v_lshl_add_u32 v40, v41, 12, v40
    v_add_u32 v40, 0x11000, v40
    s_mov_b32 s65, 0x10000
L_ep_43:
    s_mov_b32 s46, 0
    buffer_load_dwordx4 v[0:3], v40, s[16:19], s46 offen sc1
    buffer_load_dwordx4 v[4:7], v40, s[16:19], s46 offen offset:16 sc1
    s_mov_b32 s46, 16384
    buffer_load_dwordx4 v[8:11], v40, s[16:19], s46 offen sc1
    buffer_load_dwordx4 v[12:15], v40, s[16:19], s46 offen offset:16 sc1
    s_mov_b32 s46, 32768
    buffer_load_dwordx4 v[16:19], v40, s[16:19], s46 offen sc1
    buffer_load_dwordx4 v[20:23], v40, s[16:19], s46 offen offset:16 sc1
    s_mov_b32 s46, 49152
    buffer_load_dwordx4 v[24:27], v40, s[16:19], s46 offen sc1
    buffer_load_dwordx4 v[28:31], v40, s[16:19], s46 offen offset:16 sc1
    s_waitcnt vmcnt(0)
    v_xor_b32 v0, s32, v0
    v_xor_b32 v1, s32, v1
    v_or_b32 v0, v0, v1
    v_xor_b32 v2, s32, v2
    v_or_b32 v0, v0, v2
    v_xor_b32 v3, s32, v3
    v_or_b32 v0, v0, v3
    v_xor_b32 v4, s32, v4
    v_or_b32 v0, v0, v4
    v_xor_b32 v5, s32, v5
    v_or_b32 v0, v0, v5
    v_xor_b32 v6, s32, v6
    v_or_b32 v0, v0, v6
    v_xor_b32 v7, s32, v7
    v_or_b32 v0, v0, v7
    v_xor_b32 v8, s32, v8
    v_or_b32 v0, v0, v8
    v_xor_b32 v9, s32, v9
    v_or_b32 v0, v0, v9
    v_xor_b32 v10, s32, v10
    v_or_b32 v0, v0, v10
    v_xor_b32 v11, s32, v11
    v_or_b32 v0, v0, v11
    v_xor_b32 v12, s32, v12
    v_or_b32 v0, v0, v12
    v_xor_b32 v13, s32, v13
    v_or_b32 v0, v0, v13
    v_xor_b32 v14, s32, v14
    v_or_b32 v0, v0, v14
    v_xor_b32 v15, s32, v15
    v_or_b32 v0, v0, v15
    v_xor_b32 v16, s32, v16
    v_or_b32 v0, v0, v16
    v_xor_b32 v17, s32, v17
    v_or_b32 v0, v0, v17
    v_xor_b32 v18, s32, v18
    v_or_b32 v0, v0, v18
    v_xor_b32 v19, s32, v19
    v_or_b32 v0, v0, v19
    v_xor_b32 v20, s32, v20
    v_or_b32 v0, v0, v20
    v_xor_b32 v21, s32, v21
    v_or_b32 v0, v0, v21
    v_xor_b32 v22, s32, v22
    v_or_b32 v0, v0, v22
    v_xor_b32 v23, s32, v23
    v_or_b32 v0, v0, v23
    v_xor_b32 v24, s32, v24
    v_or_b32 v0, v0, v24
    v_xor_b32 v25, s32, v25
    v_or_b32 v0, v0, v25
    v_xor_b32 v26, s32, v26
    v_or_b32 v0, v0, v26
    v_xor_b32 v27, s32, v27
    v_or_b32 v0, v0, v27
    v_xor_b32 v28, s32, v28
    v_or_b32 v0, v0, v28
    v_xor_b32 v29, s32, v29
    v_or_b32 v0, v0, v29
    v_xor_b32 v30, s32, v30
    v_or_b32 v0, v0, v30
    v_xor_b32 v31, s32, v31
    v_or_b32 v0, v0, v31
    v_cmp_ne_u32 vcc, 0, v0
    s_cbranch_vccz L_epw_45
    s_sub_u32 s65, s65, 1
    s_cbranch_scc0 L_ep_43
    v_mov_b32 v41, 7
    v_mov_b32 v255, 0
    global_store_dword v255, v41, s[80:81]
L_epw_45:
    s_mov_b32 s46, 0
    v_mov_b32 v41, s32
    buffer_store_dword v41, v254, s[16:19], s46 offen sc1
L_epd_44:
    s_barrier
L_final:
    s_barrier
    ds_read_b128 v[0:3], v246 offset:0
    ds_read_b128 v[4:7], v246 offset:21504
    ds_read_b128 v[8:11], v246 offset:43008
    ds_read_b128 v[12:15], v246 offset:64512
    ds_read_b128 v[16:19], v245 offset:0
    ds_read_b128 v[20:23], v245 offset:21504
    ds_read_b128 v[24:27], v245 offset:43008
    ds_read_b128 v[28:31], v245 offset:64512
    ds_read_b128 v[32:35], v250 offset:0
    ds_read_b128 v[36:39], v250 offset:21504
    ds_read_b128 v[40:43], v250 offset:43008
    ds_read_b128 v[44:47], v250 offset:64512
    s_waitcnt vmcnt(0)
    v_lshlrev_b32 v48, 16, v80
    v_and_b32 v49, 0xffff0000, v80
    v_lshlrev_b32 v50, 16, v81
    v_and_b32 v51, 0xffff0000, v81
    s_waitcnt lgkmcnt(8)
    v_add_f32 v0, v0, v4
    v_add_f32 v1, v1, v5
    v_add_f32 v2, v2, v6
    v_add_f32 v3, v3, v7
    v_add_f32 v8, v8, v12
    v_add_f32 v9, v9, v13
    v_add_f32 v10, v10, v14
    v_add_f32 v11, v11, v15
    v_add_f32 v0, v0, v48
    v_add_f32 v1, v1, v49
    v_add_f32 v2, v2, v50
    v_add_f32 v3, v3, v51
    v_add_f32 v0, v0, v8
    v_add_f32 v1, v1, v9
    v_add_f32 v2, v2, v10
    v_add_f32 v3, v3, v11
    v_cvt_pk_bf16_f32 v0, v0, v1
    v_cvt_pk_bf16_f32 v1, v2, v3
    buffer_store_dwordx2 v[0:1], v251, s[20:23], 0 offen
    v_lshlrev_b32 v48, 16, v82
    v_and_b32 v49, 0xffff0000, v82
    v_lshlrev_b32 v50, 16, v83
    v_and_b32 v51, 0xffff0000, v83
    s_waitcnt lgkmcnt(4)
    v_add_f32 v16, v16, v20
    v_add_f32 v17, v17, v21
    v_add_f32 v18, v18, v22
    v_add_f32 v19, v19, v23
    v_add_f32 v24, v24, v28
    v_add_f32 v25, v25, v29
    v_add_f32 v26, v26, v30
    v_add_f32 v27, v27, v31
    v_add_f32 v16, v16, v48
    v_add_f32 v17, v17, v49
    v_add_f32 v18, v18, v50
    v_add_f32 v19, v19, v51
    v_add_f32 v16, v16, v24
    v_add_f32 v17, v17, v25
    v_add_f32 v18, v18, v26
    v_add_f32 v19, v19, v27
    v_cvt_pk_bf16_f32 v16, v16, v17
    v_cvt_pk_bf16_f32 v17, v18, v19
    buffer_store_dwordx2 v[16:17], v252, s[20:23], 0 offen
    v_lshlrev_b32 v48, 16, v84
    v_and_b32 v49, 0xffff0000, v84
    v_lshlrev_b32 v50, 16, v85
    v_and_b32 v51, 0xffff0000, v85
    s_waitcnt lgkmcnt(0)
    v_add_f32 v32, v32, v36
    v_add_f32 v33, v33, v37
    v_add_f32 v34, v34, v38
    v_add_f32 v35, v35, v39
    v_add_f32 v40, v40, v44
    v_add_f32 v41, v41, v45
    v_add_f32 v42, v42, v46
    v_add_f32 v43, v43, v47
    v_add_f32 v32, v32, v48
    v_add_f32 v33, v33, v49
    v_add_f32 v34, v34, v50
    v_add_f32 v35, v35, v51
    v_add_f32 v32, v32, v40
    v_add_f32 v33, v33, v41
    v_add_f32 v34, v34, v42
    v_add_f32 v35, v35, v43
    v_cvt_pk_bf16_f32 v32, v32, v33
    v_cvt_pk_bf16_f32 v33, v34, v35
    buffer_store_dwordx2 v[32:33], v253, s[20:23], 0 offen
L_end:
    s_endpgm
L_true_max:
    s_waitcnt vmcnt(0) lgkmcnt(0)
    ds_read_b128 v[136:139], v228 offset:0
    ds_read_b128 v[140:143], v228 offset:256
    ds_read_b128 v[144:147], v228 offset:512
    s_waitcnt lgkmcnt(2)
    v_mfma_f32_16x16x32_bf16 v[0:3], v[136:139], v[200:203], v[220:223]
    ds_read_b128 v[136:139], v228 offset:768
    s_waitcnt lgkmcnt(2)
    v_mfma_f32_16x16x32_bf16 v[4:7], v[140:143], v[200:203], 0
    v_mfma_f32_16x16x32_bf16 v[68:71], v[140:143], v[204:207], v[220:223]
    ds_read_b128 v[140:143], v228 offset:1024
    s_waitcnt lgkmcnt(2)
    v_mfma_f32_16x16x32_bf16 v[8:11], v[144:147], v[200:203], 0
    s_nop 0
    v_max_f32 v224, v0, v1
    v_max_f32 v225, v2, v3
    v_mfma_f32_16x16x32_bf16 v[72:75], v[144:147], v[204:207], 0
    v_max3_f32 v224, v4, v5, v224
    v_max3_f32 v225, v6, v7, v225
    ds_read_b128 v[144:147], v228 offset:1280
    s_waitcnt lgkmcnt(2)
    v_mfma_f32_16x16x32_bf16 v[12:15], v[136:139], v[200:203], 0
    v_max_f32 v226, v68, v69
    v_max_f32 v227, v70, v71
    v_mfma_f32_16x16x32_bf16 v[76:79], v[136:139], v[204:207], 0
    v_max3_f32 v224, v8, v9, v224
    v_max3_f32 v225, v10, v11, v225
    ds_read_b128 v[136:139], v228 offset:1536
    s_waitcnt lgkmcnt(2)
    v_mfma_f32_16x16x32_bf16 v[16:19], v[140:143], v[200:203], 0
    v_max3_f32 v226, v72, v73, v226
    v_max3_f32 v227, v74, v75, v227
    v_mfma_f32_16x16x32_bf16 v[80:83], v[140:143], v[204:207], 0
    v_max3_f32 v224, v12, v13, v224
    v_max3_f32 v225, v14, v15, v225
    ds_read_b128 v[140:143], v228 offset:1792
    s_waitcnt lgkmcnt(2)
    v_mfma_f32_16x16x32_bf16 v[20:23], v[144:147], v[200:203], 0
    v_max3_f32 v226, v76, v77, v226
    v_max3_f32 v227, v78, v79, v227
    v_mfma_f32_16x16x32_bf16 v[84:87], v[144:147], v[204:207], 0
    v_max3_f32 v224, v16, v17, v224
    v_max3_f32 v225, v18, v19, v225
    ds_read_b128 v[144:147], v228 offset:2048
    s_waitcnt lgkmcnt(2)
    v_mfma_f32_16x16x32_bf16 v[24:27], v[136:139], v[200:203], 0
    v_max3_f32 v226, v80, v81, v226
    v_max3_f32 v227, v82, v83, v227
    v_mfma_f32_16x16x32_bf16 v[88:91], v[136:139], v[204:207], 0
    v_max3_f32 v224, v20, v21, v224
    v_max3_f32 v225, v22, v23, v225
    ds_read_b128 v[136:139], v228 offset:2304
    s_waitcnt lgkmcnt(2)
    v_mfma_f32_16x16x32_bf16 v[28:31], v[140:143], v[200:203], 0
    v_max3_f32 v226, v84, v85, v226
    v_max3_f32 v227, v86, v87, v227
    v_mfma_f32_16x16x32_bf16 v[92:95], v[140:143], v[204:207], 0
    v_max3_f32 v224, v24, v25, v224
    v_max3_f32 v225, v26, v27, v225
    ds_read_b128 v[140:143], v228 offset:2560
    s_waitcnt lgkmcnt(2)
    v_mfma_f32_16x16x32_bf16 v[32:35], v[144:147], v[200:203], 0
    v_max3_f32 v226, v88, v89, v226
    v_max3_f32 v227, v90, v91, v227
    v_mfma_f32_16x16x32_bf16 v[96:99], v[144:147], v[204:207], 0
    v_max3_f32 v224, v28, v29, v224
    v_max3_f32 v225, v30, v31, v225
    ds_read_b128 v[144:147], v228 offset:2816
    s_waitcnt lgkmcnt(2)
    v_mfma_f32_16x16x32_bf16 v[36:39], v[136:139], v[200:203], 0
    v_max3_f32 v226, v92, v93, v226
    v_max3_f32 v227, v94, v95, v227
    v_mfma_f32_16x16x32_bf16 v[100:103], v[136:139], v[204:207], 0
    v_max3_f32 v224, v32, v33, v224
    v_max3_f32 v225, v34, v35, v225
    ds_read_b128 v[136:139], v228 offset:3072
    s_waitcnt lgkmcnt(2)
    v_mfma_f32_16x16x32_bf16 v[40:43], v[140:143], v[200:203], 0
    v_max3_f32 v226, v96, v97, v226
    v_max3_f32 v227, v98, v99, v227
    v_mfma_f32_16x16x32_bf16 v[104:107], v[140:143], v[204:207], 0
    v_max3_f32 v224, v36, v37, v224
    v_max3_f32 v225, v38, v39, v225
    ds_read_b128 v[140:143], v228 offset:3328
    s_waitcnt lgkmcnt(2)
    v_mfma_f32_16x16x32_bf16 v[44:47], v[144:147], v[200:203], 0
    v_max3_f32 v226, v100, v101, v226
    v_max3_f32 v227, v102, v103, v227
    v_mfma_f32_16x16x32_bf16 v[108:111], v[144:147], v[204:207], 0
    v_max3_f32 v224, v40, v41, v224
    v_max3_f32 v225, v42, v43, v225
    ds_read_b128 v[144:147], v228 offset:3584
    s_waitcnt lgkmcnt(2)
    v_mfma_f32_16x16x32_bf16 v[48:51], v[136:139], v[200:203], 0
    v_max3_f32 v226, v104, v105, v226
    v_max3_f32 v227, v106, v107, v227
    v_mfma_f32_16x16x32_bf16 v[112:115], v[136:139], v[204:207], 0
    v_max3_f32 v224, v44, v45, v224
    v_max3_f32 v225, v46, v47, v225
    ds_read_b128 v[136:139], v228 offset:3840
    s_waitcnt lgkmcnt(2)
    v_mfma_f32_16x16x32_bf16 v[52:55], v[140:143], v[200:203], 0
    v_max3_f32 v226, v108, v109, v226
    v_max3_f32 v227, v110, v111, v227
    v_mfma_f32_16x16x32_bf16 v[116:119], v[140:143], v[204:207], 0
    v_max3_f32 v224, v48, v49, v224
    v_max3_f32 v225, v50, v51, v225
    ds_read_b128 v[140:143], v228 offset:4096
    s_waitcnt lgkmcnt(2)
    v_mfma_f32_16x16x32_bf16 v[56:59], v[144:147], v[200:203], 0
    v_max3_f32 v226, v112, v113, v226
    v_max3_f32 v227, v114, v115, v227
    v_mfma_f32_16x16x32_bf16 v[120:123], v[144:147], v[204:207], 0
    v_max3_f32 v224, v52, v53, v224
    v_max3_f32 v225, v54, v55, v225
    ds_read_b128 v[144:147], v228 offset:4352
    s_waitcnt lgkmcnt(2)
    v_mfma_f32_16x16x32_bf16 v[60:63], v[136:139], v[200:203], 0
    v_max3_f32 v226, v116, v117, v226
    v_max3_f32 v227, v118, v119, v227
    v_mfma_f32_16x16x32_bf16 v[124:127], v[136:139], v[204:207], 0
    v_max3_f32 v224, v56, v57, v224
    v_max3_f32 v225, v58, v59, v225
    s_waitcnt lgkmcnt(1)
    v_mfma_f32_16x16x32_bf16 v[64:67], v[140:143], v[200:203], v[216:219]
    v_max3_f32 v226, v120, v121, v226
    v_max3_f32 v227, v122, v123, v227
    v_mfma_f32_16x16x32_bf16 v[128:131], v[140:143], v[204:207], 0
    v_max3_f32 v224, v60, v61, v224
    v_max3_f32 v225, v62, v63, v225
    s_waitcnt lgkmcnt(0)
    v_mfma_f32_16x16x32_bf16 v[132:135], v[144:147], v[204:207], v[216:219]
    v_max3_f32 v226, v124, v125, v226
    v_max3_f32 v227, v126, v127, v227
    ds_read_b64_tr_b16 v[152:153], v230 offset:0
    ds_read_b64_tr_b16 v[154:155], v230 offset:256
    ds_read_b64_tr_b16 v[156:157], v232 offset:0
    ds_read_b64_tr_b16 v[158:159], v232 offset:256
    v_max3_f32 v224, v64, v65, v224
    v_max3_f32 v225, v66, v67, v225
    v_max3_f32 v226, v128, v129, v226
    v_max3_f32 v227, v130, v131, v227
    v_max3_f32 v226, v132, v133, v226
    v_max3_f32 v227, v134, v135, v227
    v_max_f32 v224, v224, v225
    v_max_f32 v226, v226, v227
    v_mov_b32 v225, v224
    v_mov_b32 v227, v226
    s_nop 0
    v_permlane16_swap_b32 v224, v225
    v_permlane16_swap_b32 v226, v227
    v_max_f32 v224, v224, v225
    v_max_f32 v226, v226, v227
    v_mov_b32 v225, v224
    v_mov_b32 v227, v226
    s_nop 0
    v_permlane32_swap_b32 v224, v225
    v_permlane32_swap_b32 v226, v227
    v_max_f32 v224, v224, v225
    v_max_f32 v226, v226, v227
    v_sub_f32 v0, v0, v224
    v_sub_f32 v1, v1, v224
    v_exp_f32 v0, v0
    v_sub_f32 v2, v2, v224
    v_exp_f32 v1, v1
    ds_read_b64_tr_b16 v[160:161], v230 offset:512
    ds_read_b64_tr_b16 v[162:163], v230 offset:768
    ds_read_b64_tr_b16 v[164:165], v232 offset:512
    ds_read_b64_tr_b16 v[166:167], v232 offset:768
    v_sub_f32 v3, v3, v224
    v_exp_f32 v2, v2
    v_sub_f32 v4, v4, v224
    v_exp_f32 v3, v3
    v_sub_f32 v5, v5, v224
    v_exp_f32 v4, v4
    v_sub_f32 v6, v6, v224
    v_exp_f32 v5, v5
    v_sub_f32 v7, v7, v224
    v_exp_f32 v6, v6
    v_exp_f32 v7, v7
    v_cvt_pk_bf16_f32 v0, v0, v1
    v_cvt_pk_bf16_f32 v1, v2, v3
    v_cvt_pk_bf16_f32 v2, v4, v5
    v_cvt_pk_bf16_f32 v3, v6, v7
    v_sub_f32 v68, v68, v226
    v_sub_f32 v69, v69, v226
    v_exp_f32 v68, v68
    v_sub_f32 v70, v70, v226
    v_exp_f32 v69, v69
    s_waitcnt lgkmcnt(4)
    v_mfma_f32_16x16x32_bf16 v[168:171], v[152:155], v[0:3], 0
    v_mfma_f32_16x16x32_bf16 v[176:179], v[156:159], v[0:3], 0
    v_sub_f32 v71, v71, v226
    v_exp_f32 v70, v70
    v_exp_f32 v71, v71
    v_cvt_pk_bf16_f32 v68, v68, v69
    v_cvt_pk_bf16_f32 v69, v70, v71
    v_sub_f32 v8, v8, v224
    v_sub_f32 v9, v9, v224
    v_exp_f32 v8, v8
    v_sub_f32 v10, v10, v224
    v_exp_f32 v9, v9
    v_mfma_f32_16x16x16_bf16 v[172:175], v[154:155], v[68:69], 0
    v_mfma_f32_16x16x16_bf16 v[180:183], v[158:159], v[68:69], 0
    ds_read_b64_tr_b16 v[152:153], v230 offset:1024
    ds_read_b64_tr_b16 v[154:155], v230 offset:1280
    ds_read_b64_tr_b16 v[156:157], v232 offset:1024
    ds_read_b64_tr_b16 v[158:159], v232 offset:1280
    v_sub_f32 v11, v11, v224
    v_exp_f32 v10, v10
    v_sub_f32 v12, v12, v224
    v_exp_f32 v11, v11
    v_sub_f32 v13, v13, v224
    v_exp_f32 v12, v12
    v_sub_f32 v14, v14, v224
    v_exp_f32 v13, v13
    v_sub_f32 v15, v15, v224
    v_exp_f32 v14, v14
    v_exp_f32 v15, v15
    v_cvt_pk_bf16_f32 v8, v8, v9
    v_cvt_pk_bf16_f32 v9, v10, v11
    v_cvt_pk_bf16_f32 v10, v12, v13
    v_cvt_pk_bf16_f32 v11, v14, v15
    v_sub_f32 v72, v72, v226
    v_sub_f32 v73, v73, v226
    v_exp_f32 v72, v72
    v_sub_f32 v74, v74, v226
    v_exp_f32 v73, v73
    s_waitcnt lgkmcnt(4)
    v_mfma_f32_16x16x32_bf16 v[168:171], v[160:163], v[8:11], v[168:171]
    v_mfma_f32_16x16x32_bf16 v[176:179], v[164:167], v[8:11], v[176:179]
    v_sub_f32 v75, v75, v226
    v_exp_f32 v74, v74
    v_sub_f32 v76, v76, v226
    v_exp_f32 v75, v75
    v_sub_f32 v77, v77, v226
    v_exp_f32 v76, v76
    v_sub_f32 v78, v78, v226
    v_exp_f32 v77, v77
    v_sub_f32 v79, v79, v226
    v_exp_f32 v78, v78
    v_exp_f32 v79, v79
    v_cvt_pk_bf16_f32 v72, v72, v73
    v_cvt_pk_bf16_f32 v73, v74, v75
    v_cvt_pk_bf16_f32 v74, v76, v77
    v_cvt_pk_bf16_f32 v75, v78, v79
    v_sub_f32 v16, v16, v224
    v_sub_f32 v17, v17, v224
    v_exp_f32 v16, v16
    v_sub_f32 v18, v18, v224
    v_exp_f32 v17, v17
    v_mfma_f32_16x16x32_bf16 v[172:175], v[160:163], v[72:75], v[172:175]
    v_mfma_f32_16x16x32_bf16 v[180:183], v[164:167], v[72:75], v[180:183]
    ds_read_b64_tr_b16 v[160:161], v230 offset:1536
    ds_read_b64_tr_b16 v[162:163], v230 offset:1792
    ds_read_b64_tr_b16 v[164:165], v232 offset:1536
    ds_read_b64_tr_b16 v[166:167], v232 offset:1792
    v_sub_f32 v19, v19, v224
    v_exp_f32 v18, v18
    v_sub_f32 v20, v20, v224
    v_exp_f32 v19, v19
    v_sub_f32 v21, v21, v224
    v_exp_f32 v20, v20
    v_sub_f32 v22, v22, v224
    v_exp_f32 v21, v21
    v_sub_f32 v23, v23, v224
    v_exp_f32 v22, v22
    v_exp_f32 v23, v23
    v_cvt_pk_bf16_f32 v16, v16, v17
    v_cvt_pk_bf16_f32 v17, v18, v19
    v_cvt_pk_bf16_f32 v18, v20, v21
    v_cvt_pk_bf16_f32 v19, v22, v23
    v_sub_f32 v80, v80, v226
    v_sub_f32 v81, v81, v226
    v_exp_f32 v80, v80
    v_sub_f32 v82, v82, v226
    v_exp_f32 v81, v81
    s_waitcnt lgkmcnt(4)
    v_mfma_f32_16x16x32_bf16 v[168:171], v[152:155], v[16:19], v[168:171]
    v_mfma_f32_16x16x32_bf16 v[176:179], v[156:159], v[16:19], v[176:179]
    v_sub_f32 v83, v83, v226
    v_exp_f32 v82, v82
    v_sub_f32 v84, v84, v226
    v_exp_f32 v83, v83
    v_sub_f32 v85, v85, v226
    v_exp_f32 v84, v84
    v_sub_f32 v86, v86, v226
    v_exp_f32 v85, v85
    v_sub_f32 v87, v87, v226
    v_exp_f32 v86, v86
    v_exp_f32 v87, v87
    v_cvt_pk_bf16_f32 v80, v80, v81
    v_cvt_pk_bf16_f32 v81, v82, v83
    v_cvt_pk_bf16_f32 v82, v84, v85
    v_cvt_pk_bf16_f32 v83, v86, v87
    v_sub_f32 v24, v24, v224
    v_sub_f32 v25, v25, v224
    v_exp_f32 v24, v24
    v_sub_f32 v26, v26, v224
    v_exp_f32 v25, v25
    v_mfma_f32_16x16x32_bf16 v[172:175], v[152:155], v[80:83], v[172:175]
    v_mfma_f32_16x16x32_bf16 v[180:183], v[156:159], v[80:83], v[180:183]
    ds_read_b64_tr_b16 v[152:153], v230 offset:2048
    ds_read_b64_tr_b16 v[154:155], v230 offset:2304
    ds_read_b64_tr_b16 v[156:157], v232 offset:2048
    ds_read_b64_tr_b16 v[158:159], v232 offset:2304
    v_sub_f32 v27, v27, v224
    v_exp_f32 v26, v26
    v_sub_f32 v28, v28, v224
    v_exp_f32 v27, v27
    v_sub_f32 v29, v29, v224
    v_exp_f32 v28, v28
    v_sub_f32 v30, v30, v224
    v_exp_f32 v29, v29
    v_sub_f32 v31, v31, v224
    v_exp_f32 v30, v30
    v_exp_f32 v31, v31
    v_cvt_pk_bf16_f32 v24, v24, v25
    v_cvt_pk_bf16_f32 v25, v26, v27
    v_cvt_pk_bf16_f32 v26, v28, v29
    v_cvt_pk_bf16_f32 v27, v30, v31
    v_sub_f32 v88, v88, v226
    v_sub_f32 v89, v89, v226
    v_exp_f32 v88, v88
    v_sub_f32 v90, v90, v226
    v_exp_f32 v89, v89
    s_waitcnt lgkmcnt(4)
    v_mfma_f32_16x16x32_bf16 v[168:171], v[160:163], v[24:27], v[168:171]
    v_mfma_f32_16x16x32_bf16 v[176:179], v[164:167], v[24:27], v[176:179]
    v_sub_f32 v91, v91, v226
    v_exp_f32 v90, v90
    v_sub_f32 v92, v92, v226
    v_exp_f32 v91, v91
    v_sub_f32 v93, v93, v226
    v_exp_f32 v92, v92
    v_sub_f32 v94, v94, v226
    v_exp_f32 v93, v93
    v_sub_f32 v95, v95, v226
    v_exp_f32 v94, v94
    v_exp_f32 v95, v95
    v_cvt_pk_bf16_f32 v88, v88, v89
    v_cvt_pk_bf16_f32 v89, v90, v91
    v_cvt_pk_bf16_f32 v90, v92, v93
    v_cvt_pk_bf16_f32 v91, v94, v95
    v_sub_f32 v32, v32, v224
    v_sub_f32 v33, v33, v224
    v_exp_f32 v32, v32
    v_sub_f32 v34, v34, v224
    v_exp_f32 v33, v33
    v_mfma_f32_16x16x32_bf16 v[172:175], v[160:163], v[88:91], v[172:175]
    v_mfma_f32_16x16x32_bf16 v[180:183], v[164:167], v[88:91], v[180:183]
    ds_read_b64_tr_b16 v[160:161], v230 offset:2560
    ds_read_b64_tr_b16 v[162:163], v230 offset:2816
    ds_read_b64_tr_b16 v[164:165], v232 offset:2560
    ds_read_b64_tr_b16 v[166:167], v232 offset:2816
    v_sub_f32 v35, v35, v224
    v_exp_f32 v34, v34
    v_sub_f32 v36, v36, v224
    v_exp_f32 v35, v35
    v_sub_f32 v37, v37, v224
    v_exp_f32 v36, v36
    v_sub_f32 v38, v38, v224
    v_exp_f32 v37, v37
    v_sub_f32 v39, v39, v224
    v_exp_f32 v38, v38
    v_exp_f32 v39, v39
    v_cvt_pk_bf16_f32 v32, v32, v33
    v_cvt_pk_bf16_f32 v33, v34, v35
    v_cvt_pk_bf16_f32 v34, v36, v37
    v_cvt_pk_bf16_f32 v35, v38, v39
    v_sub_f32 v96, v96, v226
    v_sub_f32 v97, v97, v226
    v_exp_f32 v96, v96
    v_sub_f32 v98, v98, v226
    v_exp_f32 v97, v97
    s_waitcnt lgkmcnt(4)
    v_mfma_f32_16x16x32_bf16 v[168:171], v[152:155], v[32:35], v[168:171]
    v_mfma_f32_16x16x32_bf16 v[176:179], v[156:159], v[32:35], v[176:179]
    v_sub_f32 v99, v99, v226
    v_exp_f32 v98, v98
    v_sub_f32 v100, v100, v226
    v_exp_f32 v99, v99
    v_sub_f32 v101, v101, v226
    v_exp_f32 v100, v100
    v_sub_f32 v102, v102, v226
    v_exp_f32 v101, v101
    v_sub_f32 v103, v103, v226
    v_exp_f32 v102, v102
    v_exp_f32 v103, v103
    v_cvt_pk_bf16_f32 v96, v96, v97
    v_cvt_pk_bf16_f32 v97, v98, v99
    v_cvt_pk_bf16_f32 v98, v100, v101
    v_cvt_pk_bf16_f32 v99, v102, v103
    v_sub_f32 v40, v40, v224
    v_sub_f32 v41, v41, v224
    v_exp_f32 v40, v40
    v_sub_f32 v42, v42, v224
    v_exp_f32 v41, v41
    v_mfma_f32_16x16x32_bf16 v[172:175], v[152:155], v[96:99], v[172:175]
    v_mfma_f32_16x16x32_bf16 v[180:183], v[156:159], v[96:99], v[180:183]
    ds_read_b64_tr_b16 v[152:153], v230 offset:3072
    ds_read_b64_tr_b16 v[154:155], v230 offset:3328
    ds_read_b64_tr_b16 v[156:157], v232 offset:3072
    ds_read_b64_tr_b16 v[158:159], v232 offset:3328
    v_sub_f32 v43, v43, v224
    v_exp_f32 v42, v42
    v_sub_f32 v44, v44, v224
    v_exp_f32 v43, v43
    v_sub_f32 v45, v45, v224
    v_exp_f32 v44, v44
    v_sub_f32 v46, v46, v224
    v_exp_f32 v45, v45
    v_sub_f32 v47, v47, v224
    v_exp_f32 v46, v46
    v_exp_f32 v47, v47
    v_cvt_pk_bf16_f32 v40, v40, v41
    v_cvt_pk_bf16_f32 v41, v42, v43
    v_cvt_pk_bf16_f32 v42, v44, v45
    v_cvt_pk_bf16_f32 v43, v46, v47
    v_sub_f32 v104, v104, v226
    v_sub_f32 v105, v105, v226
    v_exp_f32 v104, v104
    v_sub_f32 v106, v106, v226
    v_exp_f32 v105, v105
    s_waitcnt lgkmcnt(4)
    v_mfma_f32_16x16x32_bf16 v[168:171], v[160:163], v[40:43], v[168:171]
    v_mfma_f32_16x16x32_bf16 v[176:179], v[164:167], v[40:43], v[176:179]
    v_sub_f32 v107, v107, v226
    v_exp_f32 v106, v106
    v_sub_f32 v108, v108, v226
    v_exp_f32 v107, v107
    v_sub_f32 v109, v109, v226
    v_exp_f32 v108, v108
    v_sub_f32 v110, v110, v226
    v_exp_f32 v109, v109
    v_sub_f32 v111, v111, v226
    v_exp_f32 v110, v110
    v_exp_f32 v111, v111
    v_cvt_pk_bf16_f32 v104, v104, v105
    v_cvt_pk_bf16_f32 v105, v106, v107
    v_cvt_pk_bf16_f32 v106, v108, v109
    v_cvt_pk_bf16_f32 v107, v110, v111
    v_sub_f32 v48, v48, v224
    v_sub_f32 v49, v49, v224
    v_exp_f32 v48, v48
    v_sub_f32 v50, v50, v224
    v_exp_f32 v49, v49
    v_mfma_f32_16x16x32_bf16 v[172:175], v[160:163], v[104:107], v[172:175]
    v_mfma_f32_16x16x32_bf16 v[180:183], v[164:167], v[104:107], v[180:183]
    ds_read_b64_tr_b16 v[160:161], v230 offset:3584
    ds_read_b64_tr_b16 v[162:163], v230 offset:3840
    ds_read_b64_tr_b16 v[164:165], v232 offset:3584
    ds_read_b64_tr_b16 v[166:167], v232 offset:3840
    v_sub_f32 v51, v51, v224
    v_exp_f32 v50, v50
    v_sub_f32 v52, v52, v224
    v_exp_f32 v51, v51
    v_sub_f32 v53, v53, v224
    v_exp_f32 v52, v52
    v_sub_f32 v54, v54, v224
    v_exp_f32 v53, v53
    v_sub_f32 v55, v55, v224
    v_exp_f32 v54, v54
    v_exp_f32 v55, v55
    v_cvt_pk_bf16_f32 v48, v48, v49
    v_cvt_pk_bf16_f32 v49, v50, v51
    v_cvt_pk_bf16_f32 v50, v52, v53
    v_cvt_pk_bf16_f32 v51, v54, v55
    v_sub_f32 v112, v112, v226
    v_sub_f32 v113, v113, v226
    v_exp_f32 v112, v112
    v_sub_f32 v114, v114, v226
    v_exp_f32 v113, v113
    s_waitcnt lgkmcnt(4)
    v_mfma_f32_16x16x32_bf16 v[168:171], v[152:155], v[48:51], v[168:171]
    v_mfma_f32_16x16x32_bf16 v[176:179], v[156:159], v[48:51], v[176:179]
    v_sub_f32 v115, v115, v226
    v_exp_f32 v114, v114
    v_sub_f32 v116, v116, v226
    v_exp_f32 v115, v115
    v_sub_f32 v117, v117, v226
    v_exp_f32 v116, v116
    v_sub_f32 v118, v118, v226
    v_exp_f32 v117, v117
    v_sub_f32 v119, v119, v226
    v_exp_f32 v118, v118
    v_exp_f32 v119, v119
    v_cvt_pk_bf16_f32 v112, v112, v113
    v_cvt_pk_bf16_f32 v113, v114, v115
    v_cvt_pk_bf16_f32 v114, v116, v117
    v_cvt_pk_bf16_f32 v115, v118, v119
    v_sub_f32 v56, v56, v224
    v_sub_f32 v57, v57, v224
    v_exp_f32 v56, v56
    v_sub_f32 v58, v58, v224
    v_exp_f32 v57, v57
    v_mfma_f32_16x16x32_bf16 v[172:175], v[152:155], v[112:115], v[172:175]
    v_mfma_f32_16x16x32_bf16 v[180:183], v[156:159], v[112:115], v[180:183]
    ds_read_b64_tr_b16 v[152:153], v230 offset:4096
    ds_read_b64_tr_b16 v[154:155], v230 offset:4352
    ds_read_b64_tr_b16 v[156:157], v232 offset:4096
    ds_read_b64_tr_b16 v[158:159], v232 offset:4352
    v_sub_f32 v59, v59, v224
    v_exp_f32 v58, v58
    v_sub_f32 v60, v60, v224
    v_exp_f32 v59, v59
    v_sub_f32 v61, v61, v224
    v_exp_f32 v60, v60
    v_sub_f32 v62, v62, v224
    v_exp_f32 v61, v61
    v_sub_f32 v63, v63, v224
    v_exp_f32 v62, v62
    v_exp_f32 v63, v63
    v_cvt_pk_bf16_f32 v56, v56, v57
    v_cvt_pk_bf16_f32 v57, v58, v59
    v_cvt_pk_bf16_f32 v58, v60, v61
    v_cvt_pk_bf16_f32 v59, v62, v63
    v_sub_f32 v120, v120, v226
    v_sub_f32 v121, v121, v226
    v_exp_f32 v120, v120
    v_sub_f32 v122, v122, v226
    v_exp_f32 v121, v121
    s_waitcnt lgkmcnt(4)
    v_mfma_f32_16x16x32_bf16 v[168:171], v[160:163], v[56:59], v[168:171]
    v_mfma_f32_16x16x32_bf16 v[176:179], v[164:167], v[56:59], v[176:179]
    v_sub_f32 v123, v123, v226
    v_exp_f32 v122, v122
    v_sub_f32 v124, v124, v226
    v_exp_f32 v123, v123
    v_sub_f32 v125, v125, v226
    v_exp_f32 v124, v124
    v_sub_f32 v126, v126, v226
    v_exp_f32 v125, v125
    v_sub_f32 v127, v127, v226
    v_exp_f32 v126, v126
    v_exp_f32 v127, v127
    v_cvt_pk_bf16_f32 v120, v120, v121
    v_cvt_pk_bf16_f32 v121, v122, v123
    v_cvt_pk_bf16_f32 v122, v124, v125
    v_cvt_pk_bf16_f32 v123, v126, v127
    v_sub_f32 v64, v64, v224
    v_sub_f32 v65, v65, v224
    v_exp_f32 v64, v64
    v_sub_f32 v66, v66, v224
    v_exp_f32 v65, v65
    v_mfma_f32_16x16x32_bf16 v[172:175], v[160:163], v[120:123], v[172:175]
    v_mfma_f32_16x16x32_bf16 v[180:183], v[164:167], v[120:123], v[180:183]
    v_sub_f32 v67, v67, v224
    v_exp_f32 v66, v66
    v_exp_f32 v67, v67
    v_cvt_pk_bf16_f32 v64, v64, v65
    v_cvt_pk_bf16_f32 v65, v66, v67
    v_sub_f32 v128, v128, v226
    v_sub_f32 v129, v129, v226
    v_exp_f32 v128, v128
    v_sub_f32 v130, v130, v226
    v_exp_f32 v129, v129
    s_waitcnt lgkmcnt(0)
    v_mfma_f32_16x16x16_bf16 v[168:171], v[152:153], v[64:65], v[168:171]
    v_mfma_f32_16x16x16_bf16 v[176:179], v[156:157], v[64:65], v[176:179]
    v_sub_f32 v131, v131, v226
    v_exp_f32 v130, v130
    v_sub_f32 v132, v132, v226
    v_exp_f32 v131, v131
    v_sub_f32 v133, v133, v226
    v_exp_f32 v132, v132
    v_sub_f32 v134, v134, v226
    v_exp_f32 v133, v133
    v_sub_f32 v135, v135, v226
    v_exp_f32 v134, v134
    v_exp_f32 v135, v135
    v_cvt_pk_bf16_f32 v128, v128, v129
    v_cvt_pk_bf16_f32 v129, v130, v131
    v_cvt_pk_bf16_f32 v130, v132, v133
    v_cvt_pk_bf16_f32 v131, v134, v135
    s_nop 1
    v_mfma_f32_16x16x32_bf16 v[172:175], v[152:155], v[128:131], v[172:175]
    v_mfma_f32_16x16x32_bf16 v[180:183], v[156:159], v[128:131], v[180:183]
    v_mov_b32 v236, v176
    v_mov_b32 v237, v176
    s_nop 5
    v_mov_b32 v238, v180
    v_mov_b32 v239, v180
    s_nop 0
    v_permlane32_swap_b32 v236, v237
    v_permlane32_swap_b32 v238, v239
    v_rcp_f32 v236, v237
    v_rcp_f32 v238, v239
    v_mul_f32 v168, v168, v236
    v_mul_f32 v169, v169, v236
    v_mul_f32 v170, v170, v236
    v_mul_f32 v171, v171, v236
    v_mul_f32 v172, v172, v238
    v_mul_f32 v173, v173, v238
    v_mul_f32 v174, v174, v238
    v_mul_f32 v175, v175, v238
    v_mul_f32 v176, v176, v236
    v_mul_f32 v177, v177, v236
    v_mul_f32 v178, v178, v236
    v_mul_f32 v179, v179, v236
    v_mul_f32 v180, v180, v238
    v_mul_f32 v181, v181, v238
    v_mul_f32 v182, v182, v238
    v_mul_f32 v183, v183, v238
    v_cvt_pk_bf16_f32 v168, v168, v169
    v_cvt_pk_bf16_f32 v169, v170, v171
    v_cvt_pk_bf16_f32 v170, v172, v173
    v_cvt_pk_bf16_f32 v171, v174, v175
    v_cvt_pk_bf16_f32 v176, v176, v177
    v_cvt_pk_bf16_f32 v177, v178, v179
    v_cvt_pk_bf16_f32 v178, v180, v181
    v_cvt_pk_bf16_f32 v179, v182, v183
    v_permlane16_swap_b32 v168, v170
    v_permlane16_swap_b32 v169, v171
    s_add_u32 s47, s58, 0
    buffer_store_dwordx4 v[168:171], v252, s[16:19], s47 offen sc1
    ds_read_b128 v[136:139], v229 offset:0
    ds_read_b128 v[140:143], v229 offset:256
    ds_read_b128 v[144:147], v229 offset:512
    s_waitcnt lgkmcnt(2)
    v_mfma_f32_16x16x32_bf16 v[0:3], v[136:139], v[208:211], v[220:223]
    ds_read_b128 v[136:139], v229 offset:768
    s_waitcnt lgkmcnt(2)
    v_mfma_f32_16x16x32_bf16 v[4:7], v[140:143], v[208:211], 0
    v_mfma_f32_16x16x32_bf16 v[68:71], v[140:143], v[212:215], v[220:223]
    ds_read_b128 v[140:143], v229 offset:1024
    s_waitcnt lgkmcnt(2)
    v_mfma_f32_16x16x32_bf16 v[8:11], v[144:147], v[208:211], 0
    s_nop 0
    v_max_f32 v224, v0, v1
    v_max_f32 v225, v2, v3
    v_mfma_f32_16x16x32_bf16 v[72:75], v[144:147], v[212:215], 0
    v_max3_f32 v224, v4, v5, v224
    v_max3_f32 v225, v6, v7, v225
    ds_read_b128 v[144:147], v229 offset:1280
    s_waitcnt lgkmcnt(2)
    v_mfma_f32_16x16x32_bf16 v[12:15], v[136:139], v[208:211], 0
    v_max_f32 v226, v68, v69
    v_max_f32 v227, v70, v71
    v_mfma_f32_16x16x32_bf16 v[76:79], v[136:139], v[212:215], 0
    v_max3_f32 v224, v8, v9, v224
    v_max3_f32 v225, v10, v11, v225
    ds_read_b128 v[136:139], v229 offset:1536
    s_waitcnt lgkmcnt(2)
    v_mfma_f32_16x16x32_bf16 v[16:19], v[140:143], v[208:211], 0
    v_max3_f32 v226, v72, v73, v226
    v_max3_f32 v227, v74, v75, v227
    v_mfma_f32_16x16x32_bf16 v[80:83], v[140:143], v[212:215], 0
    v_max3_f32 v224, v12, v13, v224
    v_max3_f32 v225, v14, v15, v225
    ds_read_b128 v[140:143], v229 offset:1792
    s_waitcnt lgkmcnt(2)
    v_mfma_f32_16x16x32_bf16 v[20:23], v[144:147], v[208:211], 0
    v_max3_f32 v226, v76, v77, v226
    v_max3_f32 v227, v78, v79, v227
    v_mfma_f32_16x16x32_bf16 v[84:87], v[144:147], v[212:215], 0
    v_max3_f32 v224, v16, v17, v224
    v_max3_f32 v225, v18, v19, v225
    ds_read_b128 v[144:147], v229 offset:2048
    s_waitcnt lgkmcnt(2)
    v_mfma_f32_16x16x32_bf16 v[24:27], v[136:139], v[208:211], 0
    v_max3_f32 v226, v80, v81, v226
    v_max3_f32 v227, v82, v83, v227
    v_mfma_f32_16x16x32_bf16 v[88:91], v[136:139], v[212:215], 0
    v_max3_f32 v224, v20, v21, v224
    v_max3_f32 v225, v22, v23, v225
    ds_read_b128 v[136:139], v229 offset:2304
    s_waitcnt lgkmcnt(2)
    v_mfma_f32_16x16x32_bf16 v[28:31], v[140:143], v[208:211], 0
    v_max3_f32 v226, v84, v85, v226
    v_max3_f32 v227, v86, v87, v227
    v_mfma_f32_16x16x32_bf16 v[92:95], v[140:143], v[212:215], 0
    v_max3_f32 v224, v24, v25, v224
    v_max3_f32 v225, v26, v27, v225
    ds_read_b128 v[140:143], v229 offset:2560
    s_waitcnt lgkmcnt(2)
    v_mfma_f32_16x16x32_bf16 v[32:35], v[144:147], v[208:211], 0
    v_max3_f32 v226, v88, v89, v226
    v_max3_f32 v227, v90, v91, v227
    v_mfma_f32_16x16x32_bf16 v[96:99], v[144:147], v[212:215], 0
    v_max3_f32 v224, v28, v29, v224
    v_max3_f32 v225, v30, v31, v225
    ds_read_b128 v[144:147], v229 offset:2816
    s_waitcnt lgkmcnt(2)
    v_mfma_f32_16x16x32_bf16 v[36:39], v[136:139], v[208:211], 0
    v_max3_f32 v226, v92, v93, v226
    v_max3_f32 v227, v94, v95, v227
    v_mfma_f32_16x16x32_bf16 v[100:103], v[136:139], v[212:215], 0
    v_max3_f32 v224, v32, v33, v224
    v_max3_f32 v225, v34, v35, v225
    ds_read_b128 v[136:139], v229 offset:3072
    s_waitcnt lgkmcnt(2)
    v_mfma_f32_16x16x32_bf16 v[40:43], v[140:143], v[208:211], 0
    v_max3_f32 v226, v96, v97, v226
    v_max3_f32 v227, v98, v99, v227
    v_mfma_f32_16x16x32_bf16 v[104:107], v[140:143], v[212:215], 0
    v_max3_f32 v224, v36, v37, v224
    v_max3_f32 v225, v38, v39, v225
    ds_read_b128 v[140:143], v229 offset:3328
    s_waitcnt lgkmcnt(2)
    v_mfma_f32_16x16x32_bf16 v[44:47], v[144:147], v[208:211], 0
    v_max3_f32 v226, v100, v101, v226
    v_max3_f32 v227, v102, v103, v227
    v_mfma_f32_16x16x32_bf16 v[108:111], v[144:147], v[212:215], 0
    v_max3_f32 v224, v40, v41, v224
    v_max3_f32 v225, v42, v43, v225
    ds_read_b128 v[144:147], v229 offset:3584
    s_waitcnt lgkmcnt(2)
    v_mfma_f32_16x16x32_bf16 v[48:51], v[136:139], v[208:211], 0
    v_max3_f32 v226, v104, v105, v226
    v_max3_f32 v227, v106, v107, v227
    v_mfma_f32_16x16x32_bf16 v[112:115], v[136:139], v[212:215], 0
    v_max3_f32 v224, v44, v45, v224
    v_max3_f32 v225, v46, v47, v225
    ds_read_b128 v[136:139], v229 offset:3840
    s_waitcnt lgkmcnt(2)
    v_mfma_f32_16x16x32_bf16 v[52:55], v[140:143], v[208:211], 0
    v_max3_f32 v226, v108, v109, v226
    v_max3_f32 v227, v110, v111, v227
    v_mfma_f32_16x16x32_bf16 v[116:119], v[140:143], v[212:215], 0
    v_max3_f32 v224, v48, v49, v224
    v_max3_f32 v225, v50, v51, v225
    ds_read_b128 v[140:143], v229 offset:4096
    s_waitcnt lgkmcnt(2)
    v_mfma_f32_16x16x32_bf16 v[56:59], v[144:147], v[208:211], 0
    v_max3_f32 v226, v112, v113, v226
    v_max3_f32 v227, v114, v115, v227
    v_mfma_f32_16x16x32_bf16 v[120:123], v[144:147], v[212:215], 0
    v_max3_f32 v224, v52, v53, v224
    v_max3_f32 v225, v54, v55, v225
    ds_read_b128 v[144:147], v229 offset:4352
    s_waitcnt lgkmcnt(2)
    v_mfma_f32_16x16x32_bf16 v[60:63], v[136:139], v[208:211], 0
    v_max3_f32 v226, v116, v117, v226
    v_max3_f32 v227, v118, v119, v227
    v_mfma_f32_16x16x32_bf16 v[124:127], v[136:139], v[212:215], 0
    v_max3_f32 v224, v56, v57, v224
    v_max3_f32 v225, v58, v59, v225
    s_waitcnt lgkmcnt(1)
    v_mfma_f32_16x16x32_bf16 v[64:67], v[140:143], v[208:211], v[216:219]
    v_max3_f32 v226, v120, v121, v226
    v_max3_f32 v227, v122, v123, v227
    v_mfma_f32_16x16x32_bf16 v[128:131], v[140:143], v[212:215], 0
    v_max3_f32 v224, v60, v61, v224
    v_max3_f32 v225, v62, v63, v225
    s_waitcnt lgkmcnt(0)
    v_mfma_f32_16x16x32_bf16 v[132:135], v[144:147], v[212:215], v[216:219]
    v_max3_f32 v226, v124, v125, v226
    v_max3_f32 v227, v126, v127, v227
    ds_read_b64_tr_b16 v[160:161], v231 offset:0
    ds_read_b64_tr_b16 v[162:163], v231 offset:256
    ds_read_b64_tr_b16 v[164:165], v233 offset:0
    ds_read_b64_tr_b16 v[166:167], v233 offset:256
    v_max3_f32 v224, v64, v65, v224
    v_max3_f32 v225, v66, v67, v225
    v_max3_f32 v226, v128, v129, v226
    v_max3_f32 v227, v130, v131, v227
    v_max3_f32 v226, v132, v133, v226
    v_max3_f32 v227, v134, v135, v227
    v_max_f32 v224, v224, v225
    v_max_f32 v226, v226, v227
    v_mov_b32 v225, v224
    v_mov_b32 v227, v226
    s_nop 0
    v_permlane16_swap_b32 v224, v225
    v_permlane16_swap_b32 v226, v227
    v_max_f32 v224, v224, v225
    v_max_f32 v226, v226, v227
    v_mov_b32 v225, v224
    v_mov_b32 v227, v226
    s_nop 0
    v_permlane32_swap_b32 v224, v225
    v_permlane32_swap_b32 v226, v227
    v_max_f32 v224, v224, v225
    v_max_f32 v226, v226, v227
    v_sub_f32 v0, v0, v224
    v_sub_f32 v1, v1, v224
    v_exp_f32 v0, v0
    v_sub_f32 v2, v2, v224
    v_exp_f32 v1, v1
    ds_read_b64_tr_b16 v[152:153], v231 offset:512
    ds_read_b64_tr_b16 v[154:155], v231 offset:768
    ds_read_b64_tr_b16 v[156:157], v233 offset:512
    ds_read_b64_tr_b16 v[158:159], v233 offset:768
    v_sub_f32 v3, v3, v224
    v_exp_f32 v2, v2
    v_sub_f32 v4, v4, v224
    v_exp_f32 v3, v3
    v_sub_f32 v5, v5, v224
    v_exp_f32 v4, v4
    v_sub_f32 v6, v6, v224
    v_exp_f32 v5, v5
    v_sub_f32 v7, v7, v224
    v_exp_f32 v6, v6
    v_exp_f32 v7, v7
    v_cvt_pk_bf16_f32 v0, v0, v1
    v_cvt_pk_bf16_f32 v1, v2, v3
    v_cvt_pk_bf16_f32 v2, v4, v5
    v_cvt_pk_bf16_f32 v3, v6, v7
    v_sub_f32 v68, v68, v226
    v_sub_f32 v69, v69, v226
    v_exp_f32 v68, v68
    v_sub_f32 v70, v70, v226
    v_exp_f32 v69, v69
    s_waitcnt lgkmcnt(4)
    v_mfma_f32_16x16x32_bf16 v[184:187], v[160:163], v[0:3], 0
    v_mfma_f32_16x16x32_bf16 v[192:195], v[164:167], v[0:3], 0
    v_sub_f32 v71, v71, v226
    v_exp_f32 v70, v70
    v_exp_f32 v71, v71
    v_cvt_pk_bf16_f32 v68, v68, v69
    v_cvt_pk_bf16_f32 v69, v70, v71
    v_sub_f32 v8, v8, v224
    v_sub_f32 v9, v9, v224
    v_exp_f32 v8, v8
    v_sub_f32 v10, v10, v224
    v_exp_f32 v9, v9
    v_mfma_f32_16x16x16_bf16 v[188:191], v[162:163], v[68:69], 0
    v_mfma_f32_16x16x16_bf16 v[196:199], v[166:167], v[68:69], 0
    ds_read_b64_tr_b16 v[160:161], v231 offset:1024
    ds_read_b64_tr_b16 v[162:163], v231 offset:1280
    ds_read_b64_tr_b16 v[164:165], v233 offset:1024
    ds_read_b64_tr_b16 v[166:167], v233 offset:1280
    v_sub_f32 v11, v11, v224
    v_exp_f32 v10, v10
    v_sub_f32 v12, v12, v224
    v_exp_f32 v11, v11
    v_sub_f32 v13, v13, v224
    v_exp_f32 v12, v12
    v_sub_f32 v14, v14, v224
    v_exp_f32 v13, v13
    v_sub_f32 v15, v15, v224
    v_exp_f32 v14, v14
    v_exp_f32 v15, v15
    v_cvt_pk_bf16_f32 v8, v8, v9
    v_cvt_pk_bf16_f32 v9, v10, v11
    v_cvt_pk_bf16_f32 v10, v12, v13
    v_cvt_pk_bf16_f32 v11, v14, v15
    v_sub_f32 v72, v72, v226
    v_sub_f32 v73, v73, v226
    v_exp_f32 v72, v72
    v_sub_f32 v74, v74, v226
    v_exp_f32 v73, v73
    s_waitcnt lgkmcnt(4)
    v_mfma_f32_16x16x32_bf16 v[184:187], v[152:155], v[8:11], v[184:187]
    v_mfma_f32_16x16x32_bf16 v[192:195], v[156:159], v[8:11], v[192:195]
    v_sub_f32 v75, v75, v226
    v_exp_f32 v74, v74
    v_sub_f32 v76, v76, v226
    v_exp_f32 v75, v75
    v_sub_f32 v77, v77, v226
    v_exp_f32 v76, v76
    v_sub_f32 v78, v78, v226
    v_exp_f32 v77, v77
    v_sub_f32 v79, v79, v226
    v_exp_f32 v78, v78
    v_exp_f32 v79, v79
    v_cvt_pk_bf16_f32 v72, v72, v73
    v_cvt_pk_bf16_f32 v73, v74, v75
    v_cvt_pk_bf16_f32 v74, v76, v77
    v_cvt_pk_bf16_f32 v75, v78, v79
    v_sub_f32 v16, v16, v224
    v_sub_f32 v17, v17, v224
    v_exp_f32 v16, v16
    v_sub_f32 v18, v18, v224
    v_exp_f32 v17, v17
    v_mfma_f32_16x16x32_bf16 v[188:191], v[152:155], v[72:75], v[188:191]
    v_mfma_f32_16x16x32_bf16 v[196:199], v[156:159], v[72:75], v[196:199]
    ds_read_b64_tr_b16 v[152:153], v231 offset:1536
    ds_read_b64_tr_b16 v[154:155], v231 offset:1792
    ds_read_b64_tr_b16 v[156:157], v233 offset:1536
    ds_read_b64_tr_b16 v[158:159], v233 offset:1792
    v_sub_f32 v19, v19, v224
    v_exp_f32 v18, v18
    v_sub_f32 v20, v20, v224
    v_exp_f32 v19, v19
    v_sub_f32 v21, v21, v224
    v_exp_f32 v20, v20
    v_sub_f32 v22, v22, v224
    v_exp_f32 v21, v21
    v_sub_f32 v23, v23, v224
    v_exp_f32 v22, v22
    v_exp_f32 v23, v23
    v_cvt_pk_bf16_f32 v16, v16, v17
    v_cvt_pk_bf16_f32 v17, v18, v19
    v_cvt_pk_bf16_f32 v18, v20, v21
    v_cvt_pk_bf16_f32 v19, v22, v23
    v_sub_f32 v80, v80, v226
    v_sub_f32 v81, v81, v226
    v_exp_f32 v80, v80
    v_sub_f32 v82, v82, v226
    v_exp_f32 v81, v81
    s_waitcnt lgkmcnt(4)
    v_mfma_f32_16x16x32_bf16 v[184:187], v[160:163], v[16:19], v[184:187]
    v_mfma_f32_16x16x32_bf16 v[192:195], v[164:167], v[16:19], v[192:195]
    v_sub_f32 v83, v83, v226
    v_exp_f32 v82, v82
    v_sub_f32 v84, v84, v226
    v_exp_f32 v83, v83
    v_sub_f32 v85, v85, v226
    v_exp_f32 v84, v84
    v_sub_f32 v86, v86, v226
    v_exp_f32 v85, v85
    v_sub_f32 v87, v87, v226
    v_exp_f32 v86, v86
    v_exp_f32 v87, v87
    v_cvt_pk_bf16_f32 v80, v80, v81
    v_cvt_pk_bf16_f32 v81, v82, v83
    v_cvt_pk_bf16_f32 v82, v84, v85
    v_cvt_pk_bf16_f32 v83, v86, v87
    v_sub_f32 v24, v24, v224
    v_sub_f32 v25, v25, v224
    v_exp_f32 v24, v24
    v_sub_f32 v26, v26, v224
    v_exp_f32 v25, v25
    v_mfma_f32_16x16x32_bf16 v[188:191], v[160:163], v[80:83], v[188:191]
    v_mfma_f32_16x16x32_bf16 v[196:199], v[164:167], v[80:83], v[196:199]
    ds_read_b64_tr_b16 v[160:161], v231 offset:2048
    ds_read_b64_tr_b16 v[162:163], v231 offset:2304
    ds_read_b64_tr_b16 v[164:165], v233 offset:2048
    ds_read_b64_tr_b16 v[166:167], v233 offset:2304
    v_sub_f32 v27, v27, v224
    v_exp_f32 v26, v26
    v_sub_f32 v28, v28, v224
    v_exp_f32 v27, v27
    v_sub_f32 v29, v29, v224
    v_exp_f32 v28, v28
    v_sub_f32 v30, v30, v224
    v_exp_f32 v29, v29
    v_sub_f32 v31, v31, v224
    v_exp_f32 v30, v30
    v_exp_f32 v31, v31
    v_cvt_pk_bf16_f32 v24, v24, v25
    v_cvt_pk_bf16_f32 v25, v26, v27
    v_cvt_pk_bf16_f32 v26, v28, v29
    v_cvt_pk_bf16_f32 v27, v30, v31
    v_sub_f32 v88, v88, v226
    v_sub_f32 v89, v89, v226
    v_exp_f32 v88, v88
    v_sub_f32 v90, v90, v226
    v_exp_f32 v89, v89
    s_waitcnt lgkmcnt(4)
    v_mfma_f32_16x16x32_bf16 v[184:187], v[152:155], v[24:27], v[184:187]
    v_mfma_f32_16x16x32_bf16 v[192:195], v[156:159], v[24:27], v[192:195]
    v_sub_f32 v91, v91, v226
    v_exp_f32 v90, v90
    v_sub_f32 v92, v92, v226
    v_exp_f32 v91, v91
    v_sub_f32 v93, v93, v226
    v_exp_f32 v92, v92
    v_sub_f32 v94, v94, v226
    v_exp_f32 v93, v93
    v_sub_f32 v95, v95, v226
    v_exp_f32 v94, v94
    v_exp_f32 v95, v95
    v_cvt_pk_bf16_f32 v88, v88, v89
    v_cvt_pk_bf16_f32 v89, v90, v91
    v_cvt_pk_bf16_f32 v90, v92, v93
    v_cvt_pk_bf16_f32 v91, v94, v95
    v_sub_f32 v32, v32, v224
    v_sub_f32 v33, v33, v224
    v_exp_f32 v32, v32
    v_sub_f32 v34, v34, v224
    v_exp_f32 v33, v33
    v_mfma_f32_16x16x32_bf16 v[188:191], v[152:155], v[88:91], v[188:191]
    v_mfma_f32_16x16x32_bf16 v[196:199], v[156:159], v[88:91], v[196:199]
    ds_read_b64_tr_b16 v[152:153], v231 offset:2560
    ds_read_b64_tr_b16 v[154:155], v231 offset:2816
    ds_read_b64_tr_b16 v[156:157], v233 offset:2560
    ds_read_b64_tr_b16 v[158:159], v233 offset:2816
    v_sub_f32 v35, v35, v224
    v_exp_f32 v34, v34
    v_sub_f32 v36, v36, v224
    v_exp_f32 v35, v35
    v_sub_f32 v37, v37, v224
    v_exp_f32 v36, v36
    v_sub_f32 v38, v38, v224
    v_exp_f32 v37, v37
    v_sub_f32 v39, v39, v224
    v_exp_f32 v38, v38
    v_exp_f32 v39, v39
    v_cvt_pk_bf16_f32 v32, v32, v33
    v_cvt_pk_bf16_f32 v33, v34, v35
    v_cvt_pk_bf16_f32 v34, v36, v37
    v_cvt_pk_bf16_f32 v35, v38, v39
    v_sub_f32 v96, v96, v226
    v_sub_f32 v97, v97, v226
    v_exp_f32 v96, v96
    v_sub_f32 v98, v98, v226
    v_exp_f32 v97, v97
    s_waitcnt lgkmcnt(4)
    v_mfma_f32_16x16x32_bf16 v[184:187], v[160:163], v[32:35], v[184:187]
    v_mfma_f32_16x16x32_bf16 v[192:195], v[164:167], v[32:35], v[192:195]
    v_sub_f32 v99, v99, v226
    v_exp_f32 v98, v98
    v_sub_f32 v100, v100, v226
    v_exp_f32 v99, v99
    v_sub_f32 v101, v101, v226
    v_exp_f32 v100, v100
    v_sub_f32 v102, v102, v226
    v_exp_f32 v101, v101
    v_sub_f32 v103, v103, v226
    v_exp_f32 v102, v102
    v_exp_f32 v103, v103
    v_cvt_pk_bf16_f32 v96, v96, v97
    v_cvt_pk_bf16_f32 v97, v98, v99
    v_cvt_pk_bf16_f32 v98, v100, v101
    v_cvt_pk_bf16_f32 v99, v102, v103
    v_sub_f32 v40, v40, v224
    v_sub_f32 v41, v41, v224
    v_exp_f32 v40, v40
    v_sub_f32 v42, v42, v224
    v_exp_f32 v41, v41
    v_mfma_f32_16x16x32_bf16 v[188:191], v[160:163], v[96:99], v[188:191]
    v_mfma_f32_16x16x32_bf16 v[196:199], v[164:167], v[96:99], v[196:199]
    ds_read_b64_tr_b16 v[160:161], v231 offset:3072
    ds_read_b64_tr_b16 v[162:163], v231 offset:3328
    ds_read_b64_tr_b16 v[164:165], v233 offset:3072
    ds_read_b64_tr_b16 v[166:167], v233 offset:3328
    v_sub_f32 v43, v43, v224
    v_exp_f32 v42, v42
    v_sub_f32 v44, v44, v224
    v_exp_f32 v43, v43
    v_sub_f32 v45, v45, v224
    v_exp_f32 v44, v44
    v_sub_f32 v46, v46, v224
    v_exp_f32 v45, v45
    v_sub_f32 v47, v47, v224
    v_exp_f32 v46, v46
    v_exp_f32 v47, v47
    v_cvt_pk_bf16_f32 v40, v40, v41
    v_cvt_pk_bf16_f32 v41, v42, v43
    v_cvt_pk_bf16_f32 v42, v44, v45
    v_cvt_pk_bf16_f32 v43, v46, v47
    v_sub_f32 v104, v104, v226
    v_sub_f32 v105, v105, v226
    v_exp_f32 v104, v104
    v_sub_f32 v106, v106, v226
    v_exp_f32 v105, v105
    s_waitcnt lgkmcnt(4)
    v_mfma_f32_16x16x32_bf16 v[184:187], v[152:155], v[40:43], v[184:187]
    v_mfma_f32_16x16x32_bf16 v[192:195], v[156:159], v[40:43], v[192:195]
    v_sub_f32 v107, v107, v226
    v_exp_f32 v106, v106
    v_sub_f32 v108, v108, v226
    v_exp_f32 v107, v107
    v_sub_f32 v109, v109, v226
    v_exp_f32 v108, v108
    v_sub_f32 v110, v110, v226
    v_exp_f32 v109, v109
    v_sub_f32 v111, v111, v226
    v_exp_f32 v110, v110
    v_exp_f32 v111, v111
    v_cvt_pk_bf16_f32 v104, v104, v105
    v_cvt_pk_bf16_f32 v105, v106, v107
    v_cvt_pk_bf16_f32 v106, v108, v109
    v_cvt_pk_bf16_f32 v107, v110, v111
    v_sub_f32 v48, v48, v224
    v_sub_f32 v49, v49, v224
    v_exp_f32 v48, v48
    v_sub_f32 v50, v50, v224
    v_exp_f32 v49, v49
    v_mfma_f32_16x16x32_bf16 v[188:191], v[152:155], v[104:107], v[188:191]
    v_mfma_f32_16x16x32_bf16 v[196:199], v[156:159], v[104:107], v[196:199]
    ds_read_b64_tr_b16 v[152:153], v231 offset:3584
    ds_read_b64_tr_b16 v[154:155], v231 offset:3840
    ds_read_b64_tr_b16 v[156:157], v233 offset:3584
    ds_read_b64_tr_b16 v[158:159], v233 offset:3840
    v_sub_f32 v51, v51, v224
    v_exp_f32 v50, v50
    v_sub_f32 v52, v52, v224
    v_exp_f32 v51, v51
    v_sub_f32 v53, v53, v224
    v_exp_f32 v52, v52
    v_sub_f32 v54, v54, v224
    v_exp_f32 v53, v53
    v_sub_f32 v55, v55, v224
    v_exp_f32 v54, v54
    v_exp_f32 v55, v55
    v_cvt_pk_bf16_f32 v48, v48, v49
    v_cvt_pk_bf16_f32 v49, v50, v51
    v_cvt_pk_bf16_f32 v50, v52, v53
    v_cvt_pk_bf16_f32 v51, v54, v55
    v_sub_f32 v112, v112, v226
    v_sub_f32 v113, v113, v226
    v_exp_f32 v112, v112
    v_sub_f32 v114, v114, v226
    v_exp_f32 v113, v113
    s_waitcnt lgkmcnt(4)
    v_mfma_f32_16x16x32_bf16 v[184:187], v[160:163], v[48:51], v[184:187]
    v_mfma_f32_16x16x32_bf16 v[192:195], v[164:167], v[48:51], v[192:195]
    v_sub_f32 v115, v115, v226
    v_exp_f32 v114, v114
    v_sub_f32 v116, v116, v226
    v_exp_f32 v115, v115
    v_sub_f32 v117, v117, v226
    v_exp_f32 v116, v116
    v_sub_f32 v118, v118, v226
    v_exp_f32 v117, v117
    v_sub_f32 v119, v119, v226
    v_exp_f32 v118, v118
    v_exp_f32 v119, v119
    v_cvt_pk_bf16_f32 v112, v112, v113
    v_cvt_pk_bf16_f32 v113, v114, v115
    v_cvt_pk_bf16_f32 v114, v116, v117
    v_cvt_pk_bf16_f32 v115, v118, v119
    v_sub_f32 v56, v56, v224
    v_sub_f32 v57, v57, v224
    v_exp_f32 v56, v56
    v_sub_f32 v58, v58, v224
    v_exp_f32 v57, v57
    v_mfma_f32_16x16x32_bf16 v[188:191], v[160:163], v[112:115], v[188:191]
    v_mfma_f32_16x16x32_bf16 v[196:199], v[164:167], v[112:115], v[196:199]
    ds_read_b64_tr_b16 v[160:161], v231 offset:4096
    ds_read_b64_tr_b16 v[162:163], v231 offset:4352
    ds_read_b64_tr_b16 v[164:165], v233 offset:4096
    ds_read_b64_tr_b16 v[166:167], v233 offset:4352
    v_sub_f32 v59, v59, v224
    v_exp_f32 v58, v58
    v_sub_f32 v60, v60, v224
    v_exp_f32 v59, v59
    v_sub_f32 v61, v61, v224
    v_exp_f32 v60, v60
    v_sub_f32 v62, v62, v224
    v_exp_f32 v61, v61
    v_sub_f32 v63, v63, v224
    v_exp_f32 v62, v62
    v_exp_f32 v63, v63
    v_cvt_pk_bf16_f32 v56, v56, v57
    v_cvt_pk_bf16_f32 v57, v58, v59
    v_cvt_pk_bf16_f32 v58, v60, v61
    v_cvt_pk_bf16_f32 v59, v62, v63
    v_sub_f32 v120, v120, v226
    v_sub_f32 v121, v121, v226
    v_exp_f32 v120, v120
    v_sub_f32 v122, v122, v226
    v_exp_f32 v121, v121
    s_waitcnt lgkmcnt(4)
    v_mfma_f32_16x16x32_bf16 v[184:187], v[152:155], v[56:59], v[184:187]
    v_mfma_f32_16x16x32_bf16 v[192:195], v[156:159], v[56:59], v[192:195]
    v_sub_f32 v123, v123, v226
    v_exp_f32 v122, v122
    v_sub_f32 v124, v124, v226
    v_exp_f32 v123, v123
    v_sub_f32 v125, v125, v226
    v_exp_f32 v124, v124
    v_sub_f32 v126, v126, v226
    v_exp_f32 v125, v125
    v_sub_f32 v127, v127, v226
    v_exp_f32 v126, v126
    v_exp_f32 v127, v127
    v_cvt_pk_bf16_f32 v120, v120, v121
    v_cvt_pk_bf16_f32 v121, v122, v123
    v_cvt_pk_bf16_f32 v122, v124, v125
    v_cvt_pk_bf16_f32 v123, v126, v127
    v_sub_f32 v64, v64, v224
    v_sub_f32 v65, v65, v224
    v_exp_f32 v64, v64
    v_sub_f32 v66, v66, v224
    v_exp_f32 v65, v65
    v_mfma_f32_16x16x32_bf16 v[188:191], v[152:155], v[120:123], v[188:191]
    v_mfma_f32_16x16x32_bf16 v[196:199], v[156:159], v[120:123], v[196:199]
    v_sub_f32 v67, v67, v224
    v_exp_f32 v66, v66
    v_exp_f32 v67, v67
    v_cvt_pk_bf16_f32 v64, v64, v65
    v_cvt_pk_bf16_f32 v65, v66, v67
    v_sub_f32 v128, v128, v226
    v_sub_f32 v129, v129, v226
    v_exp_f32 v128, v128
    v_sub_f32 v130, v130, v226
    v_exp_f32 v129, v129
    s_waitcnt lgkmcnt(0)
    v_mfma_f32_16x16x16_bf16 v[184:187], v[160:161], v[64:65], v[184:187]
    v_mfma_f32_16x16x16_bf16 v[192:195], v[164:165], v[64:65], v[192:195]
    v_sub_f32 v131, v131, v226
    v_exp_f32 v130, v130
    v_sub_f32 v132, v132, v226
    v_exp_f32 v131, v131
    v_sub_f32 v133, v133, v226
    v_exp_f32 v132, v132
    v_sub_f32 v134, v134, v226
    v_exp_f32 v133, v133
    v_sub_f32 v135, v135, v226
    v_exp_f32 v134, v134
    v_exp_f32 v135, v135
    v_cvt_pk_bf16_f32 v128, v128, v129
    v_cvt_pk_bf16_f32 v129, v130, v131
    v_cvt_pk_bf16_f32 v130, v132, v133
    v_cvt_pk_bf16_f32 v131, v134, v135
    s_nop 1
    v_mfma_f32_16x16x32_bf16 v[188:191], v[160:163], v[128:131], v[188:191]
    v_mfma_f32_16x16x32_bf16 v[196:199], v[164:167], v[128:131], v[196:199]
    v_mov_b32 v240, v192
    v_mov_b32 v241, v192
    s_nop 5
    v_mov_b32 v242, v196
    v_mov_b32 v243, v196
    s_nop 0
    v_permlane32_swap_b32 v240, v241
    v_permlane32_swap_b32 v242, v243
    v_rcp_f32 v240, v241
    v_rcp_f32 v242, v243
    v_mul_f32 v184, v184, v240
    v_mul_f32 v185, v185, v240
    v_mul_f32 v186, v186, v240
    v_mul_f32 v187, v187, v240
    v_mul_f32 v188, v188, v242
    v_mul_f32 v189, v189, v242
    v_mul_f32 v190, v190, v242
    v_mul_f32 v191, v191, v242
    v_mul_f32 v192, v192, v240
    v_mul_f32 v193, v193, v240
    v_mul_f32 v194, v194, v240
    v_mul_f32 v195, v195, v240
    v_mul_f32 v196, v196, v242
    v_mul_f32 v197, v197, v242
    v_mul_f32 v198, v198, v242
    v_mul_f32 v199, v199, v242
    v_cvt_pk_bf16_f32 v184, v184, v185
    v_cvt_pk_bf16_f32 v185, v186, v187
    v_cvt_pk_bf16_f32 v186, v188, v189
    v_cvt_pk_bf16_f32 v187, v190, v191
    v_cvt_pk_bf16_f32 v192, v192, v193
    v_cvt_pk_bf16_f32 v193, v194, v195
    v_cvt_pk_bf16_f32 v194, v196, v197
    v_cvt_pk_bf16_f32 v195, v198, v199
    v_permlane16_swap_b32 v184, v186
    v_permlane16_swap_b32 v185, v187
    s_add_u32 s47, s58, 6144
    buffer_store_dwordx4 v[184:187], v252, s[16:19], s47 offen sc1
    v_cndmask_b32 v192, v192, v176, s[78:79]
    v_cndmask_b32 v193, v193, v177, s[78:79]
    v_cndmask_b32 v194, v194, v178, s[78:79]
    v_cndmask_b32 v195, v195, v179, s[78:79]
    s_add_u32 s47, s58, 4096
    v_permlane16_swap_b32 v192, v194
    v_permlane16_swap_b32 v193, v195
    buffer_store_dwordx4 v[192:195], v234, s[16:19], s47 offen sc1
    s_branch L_att_done
.section .rodata,"a"
.p2align 6
.amdhsa_kernel parallel_sum__sliding_block__dense_activation_silu__prompt_kernel
  .amdhsa_next_free_vgpr 256
  .amdhsa_next_free_sgpr 102
  .amdhsa_accum_offset 256
  .amdhsa_group_segment_fixed_size 0
  .amdhsa_kernarg_size 72
  .amdhsa_user_sgpr_count 2
  .amdhsa_user_sgpr_kernarg_segment_ptr 1
  .amdhsa_system_sgpr_workgroup_id_x 1
.end_amdhsa_kernel
```
